```python
import torch

def _softmax(x, axis=-1):
    return torch.softmax(x, dim=axis)
def _gelu(x):
    return torch.nn.functional.gelu(x, approximate="tanh")
def _silu(x):
    return torch.nn.functional.silu(x)
def _sigmoid(x):
    return torch.sigmoid(x)
def _layernorm(x, axis=-1, eps=1e-5):
    m = x.mean(dim=axis, keepdim=True)
    v = x.var(dim=axis, keepdim=True, unbiased=False)
    return (x - m) / torch.sqrt(v + eps)
def _scatter_add(tgt, idx, src, axis=0):
    return tgt.clone().index_add_(axis, idx, src)
def _segment_sum(src, seg, n):
    out = torch.zeros((n,) + src.shape[1:], dtype=src.dtype)
    return out.index_add_(0, seg, src)
def _pad(x, pw):
    flat = tuple(v for pair in reversed(pw) for v in pair)
    return torch.nn.functional.pad(x, flat)

kernel_name = 'gated_mix__mha_block_cached__moe_arch_mod__decode'

def setup_inputs():

    _w = (lambda a: (lambda t: t.to(torch.bfloat16) if t.is_floating_point() else t)(torch.as_tensor(a)))
    def _A_setup():
        B, Sq, D = 4, 1, 1024
        H, Sk, Dh = 32, 8192, 128
        return {
            "x": _w((lambda *s: torch.randn(*s, dtype=torch.bfloat16) * 0.05)(B, Sq, D)),
            "k_cache": _w((lambda *s: torch.randn(*s, dtype=torch.bfloat16) * 6.4)(B, H, Sk, Dh)),
            "v_cache": _w((lambda *s: torch.randn(*s, dtype=torch.bfloat16) * 0.4)(B, H, Sk, Dh)),
            "wq": _w((lambda *s: torch.randn(*s, dtype=torch.bfloat16) * 6.4)(D, H * Dh) * (D ** -0.5)),
            "wo": _w((lambda *s: torch.randn(*s, dtype=torch.bfloat16) * 0.4)(H * Dh, D) * ((H * Dh) ** -0.5)),
        }
    _A_in = _A_setup()

    def _B_setup():
        B, S, D, F, C = 4, 1, 1024, 3584, 1
        return {
            "x": _w((lambda *s: torch.randn(*s, dtype=torch.bfloat16) * 0.05)(B, S, D)),
            "w_r": _w((lambda *s: torch.randn(*s, dtype=torch.bfloat16) * 3.2)(D)),
            "w_gate": _w((lambda *s: torch.randn(*s, dtype=torch.bfloat16) * 0.1)(D, F)),
            "w_up": _w((lambda *s: torch.randn(*s, dtype=torch.bfloat16) * 0.1)(D, F)),
            "w_down": _w((lambda *s: torch.randn(*s, dtype=torch.bfloat16) * 0.1)(F, D)),
        }
    _B_in = _B_setup()

    return {
        "A_x": _A_in["x"],
        "A_k_cache": _A_in["k_cache"],
        "A_v_cache": _A_in["v_cache"],
        "A_wq": _A_in["wq"],
        "A_wo": _A_in["wo"],
        "B_x": _B_in["x"],
        "B_w_r": _B_in["w_r"],
        "B_w_gate": _B_in["w_gate"],
        "B_w_up": _B_in["w_up"],
        "B_w_down": _B_in["w_down"],
        "gate_w": _w((lambda *s: torch.randn(*s, dtype=torch.bfloat16) * 0.05)(1024) * 16.0),
    }

def reference(A_x, A_k_cache, A_v_cache, A_wq, A_wo, B_x, B_w_r, B_w_gate, B_w_up, B_w_down, gate_w):
    def _A_ref(x, k_cache, v_cache, wq, wo):
        B, Sq, D = x.shape
        H, Dh = 32, 128
        q = (lambda x, *d: x.permute(*d))((x @ wq).reshape(B, Sq, H, Dh), 0, 2, 1, 3)
        scores = torch.einsum("bhqd,bhkd->bhqk", q, k_cache) * (Dh ** -0.5)
        p = _softmax(scores, axis=-1)
        o = torch.einsum("bhqk,bhkd->bhqd", p, v_cache)
        return (lambda x, *d: x.permute(*d))(o, 0, 2, 1, 3).reshape(B, Sq, H * Dh) @ wo

    def _B_ref(x, w_r, w_gate, w_up, w_down):
        B, S, D = x.shape
        C = 1
        r = x @ w_r
        idx = torch.argsort(-r, axis=-1)[:, :C]
        idx_e = (lambda x, n, axis: torch.repeat_interleave(x, n, dim=axis))(idx.reshape(B, C, 1), D, axis=2)
        x_sel = (lambda x, i, axis: torch.take_along_dim(x, i, dim=axis))(x, idx_e, axis=1)
        g = _silu(x_sel @ w_gate)
        u = x_sel @ w_up
        y = (g * u) @ w_down
        r_sel = _sigmoid((lambda x, i, axis: torch.take_along_dim(x, i, dim=axis))(r, idx, axis=1))
        y = y * r_sel.reshape(B, C, 1)
        b_off = (torch.arange(B) * S).reshape(B, 1)
        flat_idx = (idx + b_off).reshape(B * C)
        zero = (x * 0.0).reshape(B * S, D)
        upd = _scatter_add(zero, flat_idx, y.reshape(B * C, D), axis=0)
        return x + upd.reshape(B, S, D)

    x = A_x
    g = _sigmoid((x * gate_w).sum(-1, keepdims=True))
    a = _A_ref(x, A_k_cache, A_v_cache, A_wq, A_wo)
    b = _B_ref(x, B_w_r, B_w_gate, B_w_up, B_w_down)
    return g * a + (1 - g) * b
```

```asm
; @launch grid=(256,1,1) block=(768,1,1) lds=15360
.amdgcn_target "amdgcn-amd-amdhsa--gfx950"
.text
.globl gated_mix__mha_block_cached__moe_arch_mod__decode_kernel
.p2align 8
.type gated_mix__mha_block_cached__moe_arch_mod__decode_kernel,@function
gated_mix__mha_block_cached__moe_arch_mod__decode_kernel:
    s_cmp_ge_u32 s2, 256
    s_cbranch_scc1 L_end
    s_load_dwordx16 s[4:19], s[0:1], 0
    s_load_dwordx8 s[20:27], s[0:1], 64
    s_load_dwordx4 s[28:31], s[0:1], 96
    v_lshrrev_b32 v1, 6, v0
    v_and_b32 v0, 63, v0
    v_readfirstlane_b32 s3, v1
    s_bfe_u32 s57, s2, 0x20003
    s_bfe_u32 s58, s2, 0x20001
    s_lshr_b32 s60, s2, 5
    s_lshl_b32 s60, s60, 2
    s_or_b32 s58, s58, s60
    s_and_b32 s65, s2, 1
    s_lshl_b32 s60, s57, 1
    s_or_b32 s65, s65, s60
    s_mov_b32 s52, 0x05040100
    s_mov_b32 s53, 0x07060302
    s_mov_b32 s59, 0x3fb8aa3b
    v_lshlrev_b32 v1, 4, v0
    s_cmp_lt_u32 s3, 4
    s_cbranch_scc1 L_aux
    s_sub_u32 s3, s3, 4
    s_lshl_b32 s60, s57, 5
    s_add_u32 s60, s60, s58
    s_lshl_b32 s60, s60, 21
    s_bitcmp1_b32 s2, 0
    s_cselect_b32 s62, 255, 0
    s_cselect_b32 s63, -5, 5
    s_add_u32 s63, s63, 128
    s_mov_b32 s34, 2097152
    s_mov_b32 s35, 0x20000
    s_mov_b32 s38, s34
    s_mov_b32 s39, 0x20000
    s_mul_i32 s85, s58, 0
    s_mul_i32 s54, s57, 0
    s_add_u32 s85, s85, s54
    s_xor_b32 s54, s3, s62
    s_add_u32 s54, s54, s85
    s_and_b32 s54, s54, 255
    s_lshl_b32 s54, s54, 13
    s_add_u32 s55, s54, 4096
    s_waitcnt lgkmcnt(0)
    s_add_u32 s32, s6, s60
    s_addc_u32 s33, s7, 0
    s_add_u32 s36, s8, s60
    s_addc_u32 s37, s9, 0
    buffer_load_dwordx4 v[40:43], v1, s[32:35], s54 offen offset:0 nt
    buffer_load_dwordx4 v[44:47], v1, s[32:35], s54 offen offset:1024 nt
    buffer_load_dwordx4 v[48:51], v1, s[32:35], s54 offen offset:2048 nt
    buffer_load_dwordx4 v[52:55], v1, s[32:35], s54 offen offset:3072 nt
    buffer_load_dwordx4 v[56:59], v1, s[32:35], s55 offen offset:0 nt
    buffer_load_dwordx4 v[60:63], v1, s[32:35], s55 offen offset:1024 nt
    buffer_load_dwordx4 v[64:67], v1, s[32:35], s55 offen offset:2048 nt
    buffer_load_dwordx4 v[68:71], v1, s[32:35], s55 offen offset:3072 nt
    buffer_load_dwordx4 v[72:75], v1, s[36:39], s54 offen offset:0 nt
    buffer_load_dwordx4 v[76:79], v1, s[36:39], s54 offen offset:1024 nt
    buffer_load_dwordx4 v[80:83], v1, s[36:39], s54 offen offset:2048 nt
    buffer_load_dwordx4 v[84:87], v1, s[36:39], s54 offen offset:3072 nt
    buffer_load_dwordx4 v[88:91], v1, s[36:39], s55 offen offset:0 nt
    buffer_load_dwordx4 v[92:95], v1, s[36:39], s55 offen offset:1024 nt
    buffer_load_dwordx4 v[96:99], v1, s[36:39], s55 offen offset:2048 nt
    buffer_load_dwordx4 v[100:103], v1, s[36:39], s55 offen offset:3072 nt
    s_xor_b32 s54, s54, 0x10000
    s_xor_b32 s55, s55, 0x10000
    s_load_dword s66, s[30:31], 0
    s_mov_b32 s48, s30
    s_mov_b32 s49, s31
    s_mov_b32 s50, 6291456
    s_mov_b32 s51, 0x20000
    v_and_b32 v16, 15, v0
    v_lshlrev_b32 v16, 4, v16
    v_mov_b32 v6, 0xf149f2ca
    v_mov_b32 v7, 0
    v_mov_b32 v8, 0
    v_mov_b32 v9, 0
    v_mov_b32 v10, 0
    v_mov_b32 v11, 0
    v_mov_b32 v12, 0
    v_mov_b32 v13, 0
    v_mov_b32 v14, 0
    v_mov_b32 v15, 0
    v_mov_b32 v0, 8448
    v_mov_b32 v39, 1
    s_add_u32 s56, s3, 8
    s_waitcnt lgkmcnt(0)
    s_barrier
    ds_read_b128 v[2:5], v16 offset:8192
    s_waitcnt lgkmcnt(0)
L_att_loop:
    s_cmp_ge_u32 s56, s63
    s_cbranch_scc1 L_tail0
    s_xor_b32 s54, s56, s62
    s_add_u32 s54, s54, s85
    s_and_b32 s54, s54, 255
    s_lshl_b32 s54, s54, 13
    s_add_u32 s55, s54, 4096
    s_mov_b64 exec, 1
    ds_add_rtn_u32 v36, v0, v39
    s_mov_b64 exec, -1
    s_waitcnt vmcnt(15)
    v_dot2_f32_bf16 v16, v40, v2, 0
    v_dot2_f32_bf16 v16, v41, v3, v16
    v_dot2_f32_bf16 v16, v42, v4, v16
    v_dot2_f32_bf16 v16, v43, v5, v16
    buffer_load_dwordx4 v[40:43], v1, s[32:35], s54 offen offset:0 nt
    s_waitcnt vmcnt(15)
    v_dot2_f32_bf16 v17, v44, v2, 0
    v_dot2_f32_bf16 v17, v45, v3, v17
    v_dot2_f32_bf16 v17, v46, v4, v17
    v_dot2_f32_bf16 v17, v47, v5, v17
    buffer_load_dwordx4 v[44:47], v1, s[32:35], s54 offen offset:1024 nt
    s_waitcnt vmcnt(15)
    v_dot2_f32_bf16 v18, v48, v2, 0
    v_dot2_f32_bf16 v18, v49, v3, v18
    v_dot2_f32_bf16 v18, v50, v4, v18
    v_dot2_f32_bf16 v18, v51, v5, v18
    buffer_load_dwordx4 v[48:51], v1, s[32:35], s54 offen offset:2048 nt
    s_waitcnt vmcnt(15)
    v_dot2_f32_bf16 v19, v52, v2, 0
    v_dot2_f32_bf16 v19, v53, v3, v19
    v_dot2_f32_bf16 v19, v54, v4, v19
    v_dot2_f32_bf16 v19, v55, v5, v19
    buffer_load_dwordx4 v[52:55], v1, s[32:35], s54 offen offset:3072 nt
    s_waitcnt vmcnt(15)
    v_dot2_f32_bf16 v20, v56, v2, 0
    v_dot2_f32_bf16 v20, v57, v3, v20
    v_dot2_f32_bf16 v20, v58, v4, v20
    v_dot2_f32_bf16 v20, v59, v5, v20
    buffer_load_dwordx4 v[56:59], v1, s[32:35], s55 offen offset:0 nt
    s_waitcnt vmcnt(15)
    v_dot2_f32_bf16 v21, v60, v2, 0
    v_dot2_f32_bf16 v21, v61, v3, v21
    v_dot2_f32_bf16 v21, v62, v4, v21
    v_dot2_f32_bf16 v21, v63, v5, v21
    buffer_load_dwordx4 v[60:63], v1, s[32:35], s55 offen offset:1024 nt
    s_waitcnt vmcnt(15)
    v_dot2_f32_bf16 v22, v64, v2, 0
    v_dot2_f32_bf16 v22, v65, v3, v22
    v_dot2_f32_bf16 v22, v66, v4, v22
    v_dot2_f32_bf16 v22, v67, v5, v22
    buffer_load_dwordx4 v[64:67], v1, s[32:35], s55 offen offset:2048 nt
    s_waitcnt vmcnt(15)
    v_dot2_f32_bf16 v23, v68, v2, 0
    v_dot2_f32_bf16 v23, v69, v3, v23
    v_dot2_f32_bf16 v23, v70, v4, v23
    v_dot2_f32_bf16 v23, v71, v5, v23
    buffer_load_dwordx4 v[68:71], v1, s[32:35], s55 offen offset:3072 nt
    s_waitcnt lgkmcnt(0)
    v_readfirstlane_b32 s56, v36
    s_nop 0
    v_add_f32_dpp v16, v16, v16 row_ror:8 row_mask:0xf bank_mask:0xf
    v_add_f32_dpp v17, v17, v17 row_ror:8 row_mask:0xf bank_mask:0xf
    v_add_f32_dpp v18, v18, v18 row_ror:8 row_mask:0xf bank_mask:0xf
    v_add_f32_dpp v19, v19, v19 row_ror:8 row_mask:0xf bank_mask:0xf
    v_add_f32_dpp v20, v20, v20 row_ror:8 row_mask:0xf bank_mask:0xf
    v_add_f32_dpp v21, v21, v21 row_ror:8 row_mask:0xf bank_mask:0xf
    v_add_f32_dpp v22, v22, v22 row_ror:8 row_mask:0xf bank_mask:0xf
    v_add_f32_dpp v23, v23, v23 row_ror:8 row_mask:0xf bank_mask:0xf
    v_add_f32_dpp v16, v16, v16 row_ror:4 row_mask:0xf bank_mask:0xf
    v_add_f32_dpp v17, v17, v17 row_ror:4 row_mask:0xf bank_mask:0xf
    v_add_f32_dpp v18, v18, v18 row_ror:4 row_mask:0xf bank_mask:0xf
    v_add_f32_dpp v19, v19, v19 row_ror:4 row_mask:0xf bank_mask:0xf
    v_add_f32_dpp v20, v20, v20 row_ror:4 row_mask:0xf bank_mask:0xf
    v_add_f32_dpp v21, v21, v21 row_ror:4 row_mask:0xf bank_mask:0xf
    v_add_f32_dpp v22, v22, v22 row_ror:4 row_mask:0xf bank_mask:0xf
    v_add_f32_dpp v23, v23, v23 row_ror:4 row_mask:0xf bank_mask:0xf
    v_add_f32_dpp v16, v16, v16 row_ror:2 row_mask:0xf bank_mask:0xf
    v_add_f32_dpp v17, v17, v17 row_ror:2 row_mask:0xf bank_mask:0xf
    v_add_f32_dpp v18, v18, v18 row_ror:2 row_mask:0xf bank_mask:0xf
    v_add_f32_dpp v19, v19, v19 row_ror:2 row_mask:0xf bank_mask:0xf
    v_add_f32_dpp v20, v20, v20 row_ror:2 row_mask:0xf bank_mask:0xf
    v_add_f32_dpp v21, v21, v21 row_ror:2 row_mask:0xf bank_mask:0xf
    v_add_f32_dpp v22, v22, v22 row_ror:2 row_mask:0xf bank_mask:0xf
    v_add_f32_dpp v23, v23, v23 row_ror:2 row_mask:0xf bank_mask:0xf
    v_add_f32_dpp v16, v16, v16 row_ror:1 row_mask:0xf bank_mask:0xf
    v_add_f32_dpp v17, v17, v17 row_ror:1 row_mask:0xf bank_mask:0xf
    v_add_f32_dpp v18, v18, v18 row_ror:1 row_mask:0xf bank_mask:0xf
    v_add_f32_dpp v19, v19, v19 row_ror:1 row_mask:0xf bank_mask:0xf
    v_add_f32_dpp v20, v20, v20 row_ror:1 row_mask:0xf bank_mask:0xf
    v_add_f32_dpp v21, v21, v21 row_ror:1 row_mask:0xf bank_mask:0xf
    v_add_f32_dpp v22, v22, v22 row_ror:1 row_mask:0xf bank_mask:0xf
    v_add_f32_dpp v23, v23, v23 row_ror:1 row_mask:0xf bank_mask:0xf
    v_cvt_pk_bf16_f32 v32, v16, v17
    v_cvt_pk_bf16_f32 v33, v18, v19
    v_cvt_pk_bf16_f32 v34, v20, v21
    v_cvt_pk_bf16_f32 v35, v22, v23
    v_lshlrev_b32 v16, 16, v32
    v_and_b32 v17, 0xffff0000, v32
    v_lshlrev_b32 v18, 16, v33
    v_and_b32 v19, 0xffff0000, v33
    v_lshlrev_b32 v20, 16, v34
    v_and_b32 v21, 0xffff0000, v34
    v_lshlrev_b32 v22, 16, v35
    v_and_b32 v23, 0xffff0000, v35
    v_mul_f32 v16, 0x3db504f3, v16
    v_mul_f32 v17, 0x3db504f3, v17
    v_mul_f32 v18, 0x3db504f3, v18
    v_mul_f32 v19, 0x3db504f3, v19
    v_mul_f32 v20, 0x3db504f3, v20
    v_mul_f32 v21, 0x3db504f3, v21
    v_mul_f32 v22, 0x3db504f3, v22
    v_mul_f32 v23, 0x3db504f3, v23
    v_cvt_pk_bf16_f32 v32, v16, v17
    v_cvt_pk_bf16_f32 v33, v18, v19
    v_cvt_pk_bf16_f32 v34, v20, v21
    v_cvt_pk_bf16_f32 v35, v22, v23
    v_lshlrev_b32 v16, 16, v32
    v_and_b32 v17, 0xffff0000, v32
    v_lshlrev_b32 v18, 16, v33
    v_and_b32 v19, 0xffff0000, v33
    v_lshlrev_b32 v20, 16, v34
    v_and_b32 v21, 0xffff0000, v34
    v_lshlrev_b32 v22, 16, v35
    v_and_b32 v23, 0xffff0000, v35
    v_max3_f32 v36, v16, v17, v18
    v_max3_f32 v37, v19, v20, v21
    v_max3_f32 v36, v36, v22, v23
    v_max_f32 v36, v36, v37
    v_mul_f32 v36, s59, v36
    v_max_f32 v37, v6, v36
    v_sub_f32 v38, v6, v37
    v_exp_f32 v38, v38
    v_mov_b32 v6, v37
    v_fma_f32 v16, v16, s59, -v37
    v_fma_f32 v17, v17, s59, -v37
    v_fma_f32 v18, v18, s59, -v37
    v_fma_f32 v19, v19, s59, -v37
    v_fma_f32 v20, v20, s59, -v37
    v_fma_f32 v21, v21, s59, -v37
    v_fma_f32 v22, v22, s59, -v37
    v_fma_f32 v23, v23, s59, -v37
    v_exp_f32 v16, v16
    v_exp_f32 v17, v17
    v_exp_f32 v18, v18
    v_exp_f32 v19, v19
    v_exp_f32 v20, v20
    v_exp_f32 v21, v21
    v_exp_f32 v22, v22
    v_exp_f32 v23, v23
    v_mul_f32 v8, v8, v38
    v_mul_f32 v9, v9, v38
    v_mul_f32 v10, v10, v38
    v_mul_f32 v11, v11, v38
    v_mul_f32 v12, v12, v38
    v_mul_f32 v13, v13, v38
    v_mul_f32 v14, v14, v38
    v_mul_f32 v15, v15, v38
    v_cvt_pk_bf16_f32 v32, v16, v17
    v_cvt_pk_bf16_f32 v33, v18, v19
    v_cvt_pk_bf16_f32 v34, v20, v21
    v_cvt_pk_bf16_f32 v35, v22, v23
    v_add_f32 v16, v16, v17
    v_add_f32 v18, v18, v19
    v_add_f32 v20, v20, v21
    v_add_f32 v22, v22, v23
    v_add_f32 v16, v16, v18
    v_add_f32 v20, v20, v22
    v_fma_f32 v7, v7, v38, v16
    v_add_f32 v7, v7, v20
    s_waitcnt vmcnt(14)
    v_perm_b32 v24, v76, v72, s52
    v_perm_b32 v25, v76, v72, s53
    v_perm_b32 v26, v77, v73, s52
    v_perm_b32 v27, v77, v73, s53
    v_perm_b32 v28, v78, v74, s52
    v_perm_b32 v29, v78, v74, s53
    v_perm_b32 v30, v79, v75, s52
    v_perm_b32 v31, v79, v75, s53
    buffer_load_dwordx4 v[72:75], v1, s[36:39], s54 offen offset:0 nt
    buffer_load_dwordx4 v[76:79], v1, s[36:39], s54 offen offset:1024 nt
    v_dot2_f32_bf16 v8, v24, v32, v8
    v_dot2_f32_bf16 v9, v25, v32, v9
    v_dot2_f32_bf16 v10, v26, v32, v10
    v_dot2_f32_bf16 v11, v27, v32, v11
    v_dot2_f32_bf16 v12, v28, v32, v12
    v_dot2_f32_bf16 v13, v29, v32, v13
    v_dot2_f32_bf16 v14, v30, v32, v14
    v_dot2_f32_bf16 v15, v31, v32, v15
    s_waitcnt vmcnt(14)
    v_perm_b32 v24, v84, v80, s52
    v_perm_b32 v25, v84, v80, s53
    v_perm_b32 v26, v85, v81, s52
    v_perm_b32 v27, v85, v81, s53
    v_perm_b32 v28, v86, v82, s52
    v_perm_b32 v29, v86, v82, s53
    v_perm_b32 v30, v87, v83, s52
    v_perm_b32 v31, v87, v83, s53
    buffer_load_dwordx4 v[80:83], v1, s[36:39], s54 offen offset:2048 nt
    buffer_load_dwordx4 v[84:87], v1, s[36:39], s54 offen offset:3072 nt
    v_dot2_f32_bf16 v8, v24, v33, v8
    v_dot2_f32_bf16 v9, v25, v33, v9
    v_dot2_f32_bf16 v10, v26, v33, v10
    v_dot2_f32_bf16 v11, v27, v33, v11
    v_dot2_f32_bf16 v12, v28, v33, v12
    v_dot2_f32_bf16 v13, v29, v33, v13
    v_dot2_f32_bf16 v14, v30, v33, v14
    v_dot2_f32_bf16 v15, v31, v33, v15
    s_waitcnt vmcnt(14)
    v_perm_b32 v24, v92, v88, s52
    v_perm_b32 v25, v92, v88, s53
    v_perm_b32 v26, v93, v89, s52
    v_perm_b32 v27, v93, v89, s53
    v_perm_b32 v28, v94, v90, s52
    v_perm_b32 v29, v94, v90, s53
    v_perm_b32 v30, v95, v91, s52
    v_perm_b32 v31, v95, v91, s53
    buffer_load_dwordx4 v[88:91], v1, s[36:39], s55 offen offset:0 nt
    buffer_load_dwordx4 v[92:95], v1, s[36:39], s55 offen offset:1024 nt
    v_dot2_f32_bf16 v8, v24, v34, v8
    v_dot2_f32_bf16 v9, v25, v34, v9
    v_dot2_f32_bf16 v10, v26, v34, v10
    v_dot2_f32_bf16 v11, v27, v34, v11
    v_dot2_f32_bf16 v12, v28, v34, v12
    v_dot2_f32_bf16 v13, v29, v34, v13
    v_dot2_f32_bf16 v14, v30, v34, v14
    v_dot2_f32_bf16 v15, v31, v34, v15
    s_waitcnt vmcnt(14)
    v_perm_b32 v24, v100, v96, s52
    v_perm_b32 v25, v100, v96, s53
    v_perm_b32 v26, v101, v97, s52
    v_perm_b32 v27, v101, v97, s53
    v_perm_b32 v28, v102, v98, s52
    v_perm_b32 v29, v102, v98, s53
    v_perm_b32 v30, v103, v99, s52
    v_perm_b32 v31, v103, v99, s53
    buffer_load_dwordx4 v[96:99], v1, s[36:39], s55 offen offset:2048 nt
    buffer_load_dwordx4 v[100:103], v1, s[36:39], s55 offen offset:3072 nt
    v_dot2_f32_bf16 v8, v24, v35, v8
    v_dot2_f32_bf16 v9, v25, v35, v9
    v_dot2_f32_bf16 v10, v26, v35, v10
    v_dot2_f32_bf16 v11, v27, v35, v11
    v_dot2_f32_bf16 v12, v28, v35, v12
    v_dot2_f32_bf16 v13, v29, v35, v13
    v_dot2_f32_bf16 v14, v30, v35, v14
    v_dot2_f32_bf16 v15, v31, v35, v15
    s_branch L_att_loop
L_tail0:
    s_waitcnt vmcnt(15)
    v_dot2_f32_bf16 v16, v40, v2, 0
    v_dot2_f32_bf16 v16, v41, v3, v16
    v_dot2_f32_bf16 v16, v42, v4, v16
    v_dot2_f32_bf16 v16, v43, v5, v16
    s_waitcnt vmcnt(14)
    v_dot2_f32_bf16 v17, v44, v2, 0
    v_dot2_f32_bf16 v17, v45, v3, v17
    v_dot2_f32_bf16 v17, v46, v4, v17
    v_dot2_f32_bf16 v17, v47, v5, v17
    s_waitcnt vmcnt(13)
    v_dot2_f32_bf16 v18, v48, v2, 0
    v_dot2_f32_bf16 v18, v49, v3, v18
    v_dot2_f32_bf16 v18, v50, v4, v18
    v_dot2_f32_bf16 v18, v51, v5, v18
    s_waitcnt vmcnt(12)
    v_dot2_f32_bf16 v19, v52, v2, 0
    v_dot2_f32_bf16 v19, v53, v3, v19
    v_dot2_f32_bf16 v19, v54, v4, v19
    v_dot2_f32_bf16 v19, v55, v5, v19
    s_waitcnt vmcnt(11)
    v_dot2_f32_bf16 v20, v56, v2, 0
    v_dot2_f32_bf16 v20, v57, v3, v20
    v_dot2_f32_bf16 v20, v58, v4, v20
    v_dot2_f32_bf16 v20, v59, v5, v20
    s_waitcnt vmcnt(10)
    v_dot2_f32_bf16 v21, v60, v2, 0
    v_dot2_f32_bf16 v21, v61, v3, v21
    v_dot2_f32_bf16 v21, v62, v4, v21
    v_dot2_f32_bf16 v21, v63, v5, v21
    s_waitcnt vmcnt(9)
    v_dot2_f32_bf16 v22, v64, v2, 0
    v_dot2_f32_bf16 v22, v65, v3, v22
    v_dot2_f32_bf16 v22, v66, v4, v22
    v_dot2_f32_bf16 v22, v67, v5, v22
    s_waitcnt vmcnt(8)
    v_dot2_f32_bf16 v23, v68, v2, 0
    v_dot2_f32_bf16 v23, v69, v3, v23
    v_dot2_f32_bf16 v23, v70, v4, v23
    v_dot2_f32_bf16 v23, v71, v5, v23
    s_nop 2
    v_add_f32_dpp v16, v16, v16 row_ror:8 row_mask:0xf bank_mask:0xf
    v_add_f32_dpp v17, v17, v17 row_ror:8 row_mask:0xf bank_mask:0xf
    v_add_f32_dpp v18, v18, v18 row_ror:8 row_mask:0xf bank_mask:0xf
    v_add_f32_dpp v19, v19, v19 row_ror:8 row_mask:0xf bank_mask:0xf
    v_add_f32_dpp v20, v20, v20 row_ror:8 row_mask:0xf bank_mask:0xf
    v_add_f32_dpp v21, v21, v21 row_ror:8 row_mask:0xf bank_mask:0xf
    v_add_f32_dpp v22, v22, v22 row_ror:8 row_mask:0xf bank_mask:0xf
    v_add_f32_dpp v23, v23, v23 row_ror:8 row_mask:0xf bank_mask:0xf
    v_add_f32_dpp v16, v16, v16 row_ror:4 row_mask:0xf bank_mask:0xf
    v_add_f32_dpp v17, v17, v17 row_ror:4 row_mask:0xf bank_mask:0xf
    v_add_f32_dpp v18, v18, v18 row_ror:4 row_mask:0xf bank_mask:0xf
    v_add_f32_dpp v19, v19, v19 row_ror:4 row_mask:0xf bank_mask:0xf
    v_add_f32_dpp v20, v20, v20 row_ror:4 row_mask:0xf bank_mask:0xf
    v_add_f32_dpp v21, v21, v21 row_ror:4 row_mask:0xf bank_mask:0xf
    v_add_f32_dpp v22, v22, v22 row_ror:4 row_mask:0xf bank_mask:0xf
    v_add_f32_dpp v23, v23, v23 row_ror:4 row_mask:0xf bank_mask:0xf
    v_add_f32_dpp v16, v16, v16 row_ror:2 row_mask:0xf bank_mask:0xf
    v_add_f32_dpp v17, v17, v17 row_ror:2 row_mask:0xf bank_mask:0xf
    v_add_f32_dpp v18, v18, v18 row_ror:2 row_mask:0xf bank_mask:0xf
    v_add_f32_dpp v19, v19, v19 row_ror:2 row_mask:0xf bank_mask:0xf
    v_add_f32_dpp v20, v20, v20 row_ror:2 row_mask:0xf bank_mask:0xf
    v_add_f32_dpp v21, v21, v21 row_ror:2 row_mask:0xf bank_mask:0xf
    v_add_f32_dpp v22, v22, v22 row_ror:2 row_mask:0xf bank_mask:0xf
    v_add_f32_dpp v23, v23, v23 row_ror:2 row_mask:0xf bank_mask:0xf
    v_add_f32_dpp v16, v16, v16 row_ror:1 row_mask:0xf bank_mask:0xf
    v_add_f32_dpp v17, v17, v17 row_ror:1 row_mask:0xf bank_mask:0xf
    v_add_f32_dpp v18, v18, v18 row_ror:1 row_mask:0xf bank_mask:0xf
    v_add_f32_dpp v19, v19, v19 row_ror:1 row_mask:0xf bank_mask:0xf
    v_add_f32_dpp v20, v20, v20 row_ror:1 row_mask:0xf bank_mask:0xf
    v_add_f32_dpp v21, v21, v21 row_ror:1 row_mask:0xf bank_mask:0xf
    v_add_f32_dpp v22, v22, v22 row_ror:1 row_mask:0xf bank_mask:0xf
    v_add_f32_dpp v23, v23, v23 row_ror:1 row_mask:0xf bank_mask:0xf
    v_cvt_pk_bf16_f32 v32, v16, v17
    v_cvt_pk_bf16_f32 v33, v18, v19
    v_cvt_pk_bf16_f32 v34, v20, v21
    v_cvt_pk_bf16_f32 v35, v22, v23
    v_lshlrev_b32 v16, 16, v32
    v_and_b32 v17, 0xffff0000, v32
    v_lshlrev_b32 v18, 16, v33
    v_and_b32 v19, 0xffff0000, v33
    v_lshlrev_b32 v20, 16, v34
    v_and_b32 v21, 0xffff0000, v34
    v_lshlrev_b32 v22, 16, v35
    v_and_b32 v23, 0xffff0000, v35
    v_mul_f32 v16, 0x3db504f3, v16
    v_mul_f32 v17, 0x3db504f3, v17
    v_mul_f32 v18, 0x3db504f3, v18
    v_mul_f32 v19, 0x3db504f3, v19
    v_mul_f32 v20, 0x3db504f3, v20
    v_mul_f32 v21, 0x3db504f3, v21
    v_mul_f32 v22, 0x3db504f3, v22
    v_mul_f32 v23, 0x3db504f3, v23
    v_cvt_pk_bf16_f32 v32, v16, v17
    v_cvt_pk_bf16_f32 v33, v18, v19
    v_cvt_pk_bf16_f32 v34, v20, v21
    v_cvt_pk_bf16_f32 v35, v22, v23
    v_lshlrev_b32 v16, 16, v32
    v_and_b32 v17, 0xffff0000, v32
    v_lshlrev_b32 v18, 16, v33
    v_and_b32 v19, 0xffff0000, v33
    v_lshlrev_b32 v20, 16, v34
    v_and_b32 v21, 0xffff0000, v34
    v_lshlrev_b32 v22, 16, v35
    v_and_b32 v23, 0xffff0000, v35
    v_max3_f32 v36, v16, v17, v18
    v_max3_f32 v37, v19, v20, v21
    v_max3_f32 v36, v36, v22, v23
    v_max_f32 v36, v36, v37
    v_mul_f32 v36, s59, v36
    v_max_f32 v37, v6, v36
    v_sub_f32 v38, v6, v37
    v_exp_f32 v38, v38
    v_mov_b32 v6, v37
    v_fma_f32 v16, v16, s59, -v37
    v_fma_f32 v17, v17, s59, -v37
    v_fma_f32 v18, v18, s59, -v37
    v_fma_f32 v19, v19, s59, -v37
    v_fma_f32 v20, v20, s59, -v37
    v_fma_f32 v21, v21, s59, -v37
    v_fma_f32 v22, v22, s59, -v37
    v_fma_f32 v23, v23, s59, -v37
    v_exp_f32 v16, v16
    v_exp_f32 v17, v17
    v_exp_f32 v18, v18
    v_exp_f32 v19, v19
    v_exp_f32 v20, v20
    v_exp_f32 v21, v21
    v_exp_f32 v22, v22
    v_exp_f32 v23, v23
    v_mul_f32 v8, v8, v38
    v_mul_f32 v9, v9, v38
    v_mul_f32 v10, v10, v38
    v_mul_f32 v11, v11, v38
    v_mul_f32 v12, v12, v38
    v_mul_f32 v13, v13, v38
    v_mul_f32 v14, v14, v38
    v_mul_f32 v15, v15, v38
    v_cvt_pk_bf16_f32 v32, v16, v17
    v_cvt_pk_bf16_f32 v33, v18, v19
    v_cvt_pk_bf16_f32 v34, v20, v21
    v_cvt_pk_bf16_f32 v35, v22, v23
    v_add_f32 v16, v16, v17
    v_add_f32 v18, v18, v19
    v_add_f32 v20, v20, v21
    v_add_f32 v22, v22, v23
    v_add_f32 v16, v16, v18
    v_add_f32 v20, v20, v22
    v_fma_f32 v7, v7, v38, v16
    v_add_f32 v7, v7, v20
    s_waitcnt vmcnt(6)
    v_perm_b32 v24, v76, v72, s52
    v_perm_b32 v25, v76, v72, s53
    v_perm_b32 v26, v77, v73, s52
    v_perm_b32 v27, v77, v73, s53
    v_perm_b32 v28, v78, v74, s52
    v_perm_b32 v29, v78, v74, s53
    v_perm_b32 v30, v79, v75, s52
    v_perm_b32 v31, v79, v75, s53
    v_dot2_f32_bf16 v8, v24, v32, v8
    v_dot2_f32_bf16 v9, v25, v32, v9
    v_dot2_f32_bf16 v10, v26, v32, v10
    v_dot2_f32_bf16 v11, v27, v32, v11
    v_dot2_f32_bf16 v12, v28, v32, v12
    v_dot2_f32_bf16 v13, v29, v32, v13
    v_dot2_f32_bf16 v14, v30, v32, v14
    v_dot2_f32_bf16 v15, v31, v32, v15
    s_waitcnt vmcnt(4)
    v_perm_b32 v24, v84, v80, s52
    v_perm_b32 v25, v84, v80, s53
    v_perm_b32 v26, v85, v81, s52
    v_perm_b32 v27, v85, v81, s53
    v_perm_b32 v28, v86, v82, s52
    v_perm_b32 v29, v86, v82, s53
    v_perm_b32 v30, v87, v83, s52
    v_perm_b32 v31, v87, v83, s53
    v_dot2_f32_bf16 v8, v24, v33, v8
    v_dot2_f32_bf16 v9, v25, v33, v9
    v_dot2_f32_bf16 v10, v26, v33, v10
    v_dot2_f32_bf16 v11, v27, v33, v11
    v_dot2_f32_bf16 v12, v28, v33, v12
    v_dot2_f32_bf16 v13, v29, v33, v13
    v_dot2_f32_bf16 v14, v30, v33, v14
    v_dot2_f32_bf16 v15, v31, v33, v15
    s_waitcnt vmcnt(2)
    v_perm_b32 v24, v92, v88, s52
    v_perm_b32 v25, v92, v88, s53
    v_perm_b32 v26, v93, v89, s52
    v_perm_b32 v27, v93, v89, s53
    v_perm_b32 v28, v94, v90, s52
    v_perm_b32 v29, v94, v90, s53
    v_perm_b32 v30, v95, v91, s52
    v_perm_b32 v31, v95, v91, s53
    v_dot2_f32_bf16 v8, v24, v34, v8
    v_dot2_f32_bf16 v9, v25, v34, v9
    v_dot2_f32_bf16 v10, v26, v34, v10
    v_dot2_f32_bf16 v11, v27, v34, v11
    v_dot2_f32_bf16 v12, v28, v34, v12
    v_dot2_f32_bf16 v13, v29, v34, v13
    v_dot2_f32_bf16 v14, v30, v34, v14
    v_dot2_f32_bf16 v15, v31, v34, v15
    s_waitcnt vmcnt(0)
    v_perm_b32 v24, v100, v96, s52
    v_perm_b32 v25, v100, v96, s53
    v_perm_b32 v26, v101, v97, s52
    v_perm_b32 v27, v101, v97, s53
    v_perm_b32 v28, v102, v98, s52
    v_perm_b32 v29, v102, v98, s53
    v_perm_b32 v30, v103, v99, s52
    v_perm_b32 v31, v103, v99, s53
    v_dot2_f32_bf16 v8, v24, v35, v8
    v_dot2_f32_bf16 v9, v25, v35, v9
    v_dot2_f32_bf16 v10, v26, v35, v10
    v_dot2_f32_bf16 v11, v27, v35, v11
    v_dot2_f32_bf16 v12, v28, v35, v12
    v_dot2_f32_bf16 v13, v29, v35, v13
    v_dot2_f32_bf16 v14, v30, v35, v14
    v_dot2_f32_bf16 v15, v31, v35, v15
L_att_fin:
    v_lshrrev_b32 v0, 4, v1
    v_mov_b32 v16, v6
    v_mov_b32 v17, v16
    s_nop 1
    v_permlane32_swap_b32 v16, v17
    v_max_f32 v16, v16, v17
    v_mov_b32 v17, v16
    s_nop 1
    v_permlane16_swap_b32 v16, v17
    v_max_f32 v16, v16, v17
    v_sub_f32 v17, v6, v16
    v_exp_f32 v17, v17
    s_nop 0
    v_mul_f32 v8, v8, v17
    v_mul_f32 v9, v9, v17
    v_mul_f32 v10, v10, v17
    v_mul_f32 v11, v11, v17
    v_mul_f32 v12, v12, v17
    v_mul_f32 v13, v13, v17
    v_mul_f32 v14, v14, v17
    v_mul_f32 v15, v15, v17
    v_mul_f32 v7, v7, v17
    s_nop 1
    v_permlane32_swap_b32 v8, v12
    v_permlane32_swap_b32 v9, v13
    v_permlane32_swap_b32 v10, v14
    v_permlane32_swap_b32 v11, v15
    v_add_f32 v8, v8, v12
    v_add_f32 v9, v9, v13
    v_add_f32 v10, v10, v14
    v_add_f32 v11, v11, v15
    s_nop 1
    v_permlane16_swap_b32 v8, v10
    v_permlane16_swap_b32 v9, v11
    v_add_f32 v8, v8, v10
    v_add_f32 v9, v9, v11
    v_mov_b32 v17, v7
    s_nop 1
    v_permlane32_swap_b32 v7, v17
    v_add_f32 v7, v7, v17
    v_mov_b32 v17, v7
    s_nop 1
    v_permlane16_swap_b32 v7, v17
    v_add_f32 v7, v7, v17
    v_mov_b32 v10, v16
    v_mov_b32 v11, v7
    v_and_b32 v16, 15, v0
    v_lshrrev_b32 v17, 4, v0
    v_lshl_add_u32 v16, v16, 2, v17
    v_lshlrev_b32 v16, 4, v16
    s_lshl_b32 s60, s3, 10
    v_add_u32 v16, s60, v16
    ds_write_b128 v16, v[8:11] offset:0
    s_waitcnt lgkmcnt(0)
    s_barrier
    s_cmp_lg_u32 s3, 0
    s_cbranch_scc1 L_end
    ds_read_b128 v[104:107], v1 offset:0
    ds_read_b128 v[108:111], v1 offset:1024
    ds_read_b128 v[112:115], v1 offset:2048
    ds_read_b128 v[116:119], v1 offset:3072
    ds_read_b128 v[120:123], v1 offset:4096
    ds_read_b128 v[124:127], v1 offset:5120
    ds_read_b128 v[128:131], v1 offset:6144
    ds_read_b128 v[132:135], v1 offset:7168
    s_mul_i32 s66, s66, 0x19660d
    s_add_u32 s66, s66, 0x3c6ef35f
    s_and_b32 s67, s66, 0xffff
    s_lshl_b32 s61, s58, 3
    s_add_u32 s61, s61, s65
    s_lshl_b32 s61, s61, 10
    s_add_u32 s61, s61, 4096
    s_mov_b32 s63, 0x07060100
    v_mov_b32 v14, s67
    s_waitcnt lgkmcnt(0)
    v_max3_f32 v10, v106, v110, v114
    v_max3_f32 v16, v118, v122, v126
    v_max3_f32 v10, v10, v130, v134
    v_max_f32 v10, v10, v16
    v_sub_f32 v16, v106, v10
    v_sub_f32 v17, v110, v10
    v_sub_f32 v18, v114, v10
    v_sub_f32 v19, v118, v10
    v_sub_f32 v20, v122, v10
    v_sub_f32 v21, v126, v10
    v_sub_f32 v22, v130, v10
    v_sub_f32 v23, v134, v10
    v_exp_f32 v16, v16
    v_exp_f32 v17, v17
    v_exp_f32 v18, v18
    v_exp_f32 v19, v19
    v_exp_f32 v20, v20
    v_exp_f32 v21, v21
    v_exp_f32 v22, v22
    v_exp_f32 v23, v23
    v_mul_f32 v11, v107, v16
    v_mul_f32 v8, v104, v16
    v_mul_f32 v9, v105, v16
    v_fma_f32 v11, v111, v17, v11
    v_fma_f32 v8, v108, v17, v8
    v_fma_f32 v9, v109, v17, v9
    v_fma_f32 v11, v115, v18, v11
    v_fma_f32 v8, v112, v18, v8
    v_fma_f32 v9, v113, v18, v9
    v_fma_f32 v11, v119, v19, v11
    v_fma_f32 v8, v116, v19, v8
    v_fma_f32 v9, v117, v19, v9
    v_fma_f32 v11, v123, v20, v11
    v_fma_f32 v8, v120, v20, v8
    v_fma_f32 v9, v121, v20, v9
    v_fma_f32 v11, v127, v21, v11
    v_fma_f32 v8, v124, v21, v8
    v_fma_f32 v9, v125, v21, v9
    v_fma_f32 v11, v131, v22, v11
    v_fma_f32 v8, v128, v22, v8
    v_fma_f32 v9, v129, v22, v9
    v_fma_f32 v11, v135, v23, v11
    v_fma_f32 v8, v132, v23, v8
    v_fma_f32 v9, v133, v23, v9
    v_log_f32 v13, v11
    v_rcp_f32 v12, v11
    s_nop 0
    v_add_f32 v13, v10, v13
    v_mul_f32 v8, v8, v12
    v_mul_f32 v9, v9, v12
    v_perm_b32 v10, v13, v14, s63
    v_perm_b32 v11, v13, v14, s52
    buffer_store_dwordx4 v[8:11], v1, s[48:51], s61 offen sc1
    s_endpgm
L_aux:
    s_mov_b32 s86, 0x07060500
    s_mov_b32 s87, 0x07060501
    s_mov_b32 s88, 0x0c0c0400
    s_mov_b32 s43, 0x20000
    s_mov_b32 s46, 8192
    s_mov_b32 s47, 0x20000
    s_mov_b32 s50, 6291456
    s_mov_b32 s51, 0x20000
    s_cmp_lg_u32 s3, 0
    s_cbranch_scc1 L_aux123
    v_lshrrev_b32 v8, 4, v0
    v_and_b32 v9, 15, v0
    v_mul_u32_u24 v6, 65536, v8
    v_lshl_add_u32 v6, v9, 4, v6
    s_lshl_b32 s62, s65, 20
    s_lshl_b32 s60, s58, 8
    s_add_u32 s62, s62, s60
    s_mov_b32 s42, 8388608
    s_waitcnt lgkmcnt(0)
    s_mov_b32 s40, s10
    s_mov_b32 s41, s11
    s_mov_b32 s44, s4
    s_mov_b32 s45, s5
    v_lshlrev_b32 v10, 11, v8
    v_lshl_add_u32 v10, v9, 4, v10
    s_lshl_b32 s63, s65, 8
    buffer_load_dwordx4 v[2:5], v10, s[44:47], s63 offen
    buffer_load_dwordx4 v[40:43], v6, s[40:43], s62 offen nt
    s_add_u32 s62, s62, 8192
    buffer_load_dwordx4 v[44:47], v6, s[40:43], s62 offen nt
    s_add_u32 s62, s62, 8192
    buffer_load_dwordx4 v[48:51], v6, s[40:43], s62 offen nt
    s_add_u32 s62, s62, 8192
    buffer_load_dwordx4 v[52:55], v6, s[40:43], s62 offen nt
    s_add_u32 s62, s62, 8192
    buffer_load_dwordx4 v[56:59], v6, s[40:43], s62 offen nt
    s_add_u32 s62, s62, 8192
    buffer_load_dwordx4 v[60:63], v6, s[40:43], s62 offen nt
    s_add_u32 s62, s62, 8192
    buffer_load_dwordx4 v[64:67], v6, s[40:43], s62 offen nt
    s_add_u32 s62, s62, 8192
    buffer_load_dwordx4 v[68:71], v6, s[40:43], s62 offen nt
    s_add_u32 s62, s62, 204800
    buffer_load_dwordx4 v[72:75], v6, s[40:43], s62 offen nt
    s_add_u32 s62, s62, 8192
    buffer_load_dwordx4 v[76:79], v6, s[40:43], s62 offen nt
    s_add_u32 s62, s62, 8192
    buffer_load_dwordx4 v[80:83], v6, s[40:43], s62 offen nt
    s_add_u32 s62, s62, 8192
    buffer_load_dwordx4 v[84:87], v6, s[40:43], s62 offen nt
    s_add_u32 s62, s62, 8192
    buffer_load_dwordx4 v[88:91], v6, s[40:43], s62 offen nt
    s_add_u32 s62, s62, 8192
    buffer_load_dwordx4 v[92:95], v6, s[40:43], s62 offen nt
    s_add_u32 s62, s62, 8192
    buffer_load_dwordx4 v[96:99], v6, s[40:43], s62 offen nt
    s_add_u32 s62, s62, 8192
    buffer_load_dwordx4 v[100:103], v6, s[40:43], s62 offen nt
    s_add_u32 s62, s62, 204800
    buffer_load_dwordx4 v[104:107], v6, s[40:43], s62 offen nt
    s_add_u32 s62, s62, 8192
    buffer_load_dwordx4 v[108:111], v6, s[40:43], s62 offen nt
    s_add_u32 s62, s62, 8192
    buffer_load_dwordx4 v[112:115], v6, s[40:43], s62 offen nt
    s_add_u32 s62, s62, 8192
    buffer_load_dwordx4 v[116:119], v6, s[40:43], s62 offen nt
    s_add_u32 s62, s62, 8192
    buffer_load_dwordx4 v[120:123], v6, s[40:43], s62 offen nt
    s_add_u32 s62, s62, 8192
    buffer_load_dwordx4 v[124:127], v6, s[40:43], s62 offen nt
    s_add_u32 s62, s62, 8192
    buffer_load_dwordx4 v[128:131], v6, s[40:43], s62 offen nt
    s_add_u32 s62, s62, 8192
    buffer_load_dwordx4 v[132:135], v6, s[40:43], s62 offen nt
    s_add_u32 s62, s62, 204800
    buffer_load_dwordx4 v[136:139], v6, s[40:43], s62 offen nt
    s_add_u32 s62, s62, 8192
    buffer_load_dwordx4 v[140:143], v6, s[40:43], s62 offen nt
    s_add_u32 s62, s62, 8192
    buffer_load_dwordx4 v[144:147], v6, s[40:43], s62 offen nt
    s_add_u32 s62, s62, 8192
    buffer_load_dwordx4 v[148:151], v6, s[40:43], s62 offen nt
    s_add_u32 s62, s62, 8192
    buffer_load_dwordx4 v[152:155], v6, s[40:43], s62 offen nt
    s_add_u32 s62, s62, 8192
    buffer_load_dwordx4 v[156:159], v6, s[40:43], s62 offen nt
    s_add_u32 s62, s62, 8192
    buffer_load_dwordx4 v[160:163], v6, s[40:43], s62 offen nt
    s_add_u32 s62, s62, 8192
    buffer_load_dwordx4 v[164:167], v6, s[40:43], s62 offen nt
    v_mov_b32 v12, 8448
    v_mov_b32 v13, 16
    ds_write_b32 v12, v13
    s_load_dword s66, s[30:31], 0
    s_mov_b32 s48, s30
    s_mov_b32 s49, s31
    v_bfe_u32 v7, v0, 2, 2
    v_lshlrev_b32 v7, 8, v7
    v_lshrrev_b32 v11, 4, v0
    v_lshl_add_u32 v7, v11, 4, v7
    s_waitcnt vmcnt(32)
    ds_write_b128 v1, v[2:5] offset:9216
    s_waitcnt lgkmcnt(0)
    s_mul_i32 s66, s66, 0x19660d
    s_add_u32 s66, s66, 0x3c6ef35f
    s_and_b32 s67, s66, 0xffff
    s_lshl_b32 s63, s58, 3
    s_add_u32 s63, s63, s65
    s_lshl_b32 s63, s63, 11
    s_add_u32 s63, s63, 1048576
    v_lshrrev_b32 v4, 4, v0
    v_and_b32 v5, 15, v0
    v_lshlrev_b32 v5, 4, v5
    v_lshl_add_u32 v2, v4, 10, v5
    v_and_b32 v4, 1, v4
    v_lshl_add_u32 v3, v4, 3, v5
    s_waitcnt vmcnt(30)
    v_perm_b32 v8, v44, v40, s52
    v_perm_b32 v12, v44, v40, s53
    v_perm_b32 v16, v45, v41, s52
    v_perm_b32 v20, v45, v41, s53
    v_perm_b32 v24, v46, v42, s52
    v_perm_b32 v28, v46, v42, s53
    v_perm_b32 v32, v47, v43, s52
    v_perm_b32 v36, v47, v43, s53
    s_waitcnt vmcnt(28)
    v_perm_b32 v9, v52, v48, s52
    v_perm_b32 v13, v52, v48, s53
    v_perm_b32 v17, v53, v49, s52
    v_perm_b32 v21, v53, v49, s53
    v_perm_b32 v25, v54, v50, s52
    v_perm_b32 v29, v54, v50, s53
    v_perm_b32 v33, v55, v51, s52
    v_perm_b32 v37, v55, v51, s53
    s_waitcnt vmcnt(26)
    v_perm_b32 v10, v60, v56, s52
    v_perm_b32 v14, v60, v56, s53
    v_perm_b32 v18, v61, v57, s52
    v_perm_b32 v22, v61, v57, s53
    v_perm_b32 v26, v62, v58, s52
    v_perm_b32 v30, v62, v58, s53
    v_perm_b32 v34, v63, v59, s52
    v_perm_b32 v38, v63, v59, s53
    s_waitcnt vmcnt(24)
    v_perm_b32 v11, v68, v64, s52
    v_perm_b32 v15, v68, v64, s53
    v_perm_b32 v19, v69, v65, s52
    v_perm_b32 v23, v69, v65, s53
    v_perm_b32 v27, v70, v66, s52
    v_perm_b32 v31, v70, v66, s53
    v_perm_b32 v35, v71, v67, s52
    v_perm_b32 v39, v71, v67, s53
    s_waitcnt vmcnt(22)
    v_perm_b32 v40, v76, v72, s52
    v_perm_b32 v44, v76, v72, s53
    v_perm_b32 v48, v77, v73, s52
    v_perm_b32 v52, v77, v73, s53
    v_perm_b32 v56, v78, v74, s52
    v_perm_b32 v60, v78, v74, s53
    v_perm_b32 v64, v79, v75, s52
    v_perm_b32 v68, v79, v75, s53
    s_waitcnt vmcnt(20)
    v_perm_b32 v41, v84, v80, s52
    v_perm_b32 v45, v84, v80, s53
    v_perm_b32 v49, v85, v81, s52
    v_perm_b32 v53, v85, v81, s53
    v_perm_b32 v57, v86, v82, s52
    v_perm_b32 v61, v86, v82, s53
    v_perm_b32 v65, v87, v83, s52
    v_perm_b32 v69, v87, v83, s53
    s_waitcnt vmcnt(18)
    v_perm_b32 v42, v92, v88, s52
    v_perm_b32 v46, v92, v88, s53
    v_perm_b32 v50, v93, v89, s52
    v_perm_b32 v54, v93, v89, s53
    v_perm_b32 v58, v94, v90, s52
    v_perm_b32 v62, v94, v90, s53
    v_perm_b32 v66, v95, v91, s52
    v_perm_b32 v70, v95, v91, s53
    s_waitcnt vmcnt(16)
    v_perm_b32 v43, v100, v96, s52
    v_perm_b32 v47, v100, v96, s53
    v_perm_b32 v51, v101, v97, s52
    v_perm_b32 v55, v101, v97, s53
    v_perm_b32 v59, v102, v98, s52
    v_perm_b32 v63, v102, v98, s53
    v_perm_b32 v67, v103, v99, s52
    v_perm_b32 v71, v103, v99, s53
    s_waitcnt vmcnt(14)
    v_perm_b32 v72, v108, v104, s52
    v_perm_b32 v76, v108, v104, s53
    v_perm_b32 v80, v109, v105, s52
    v_perm_b32 v84, v109, v105, s53
    v_perm_b32 v88, v110, v106, s52
    v_perm_b32 v92, v110, v106, s53
    v_perm_b32 v96, v111, v107, s52
    v_perm_b32 v100, v111, v107, s53
    s_waitcnt vmcnt(12)
    v_perm_b32 v73, v116, v112, s52
    v_perm_b32 v77, v116, v112, s53
    v_perm_b32 v81, v117, v113, s52
    v_perm_b32 v85, v117, v113, s53
    v_perm_b32 v89, v118, v114, s52
    v_perm_b32 v93, v118, v114, s53
    v_perm_b32 v97, v119, v115, s52
    v_perm_b32 v101, v119, v115, s53
    s_waitcnt vmcnt(10)
    v_perm_b32 v74, v124, v120, s52
    v_perm_b32 v78, v124, v120, s53
    v_perm_b32 v82, v125, v121, s52
    v_perm_b32 v86, v125, v121, s53
    v_perm_b32 v90, v126, v122, s52
    v_perm_b32 v94, v126, v122, s53
    v_perm_b32 v98, v127, v123, s52
    v_perm_b32 v102, v127, v123, s53
    s_waitcnt vmcnt(8)
    v_perm_b32 v75, v132, v128, s52
    v_perm_b32 v79, v132, v128, s53
    v_perm_b32 v83, v133, v129, s52
    v_perm_b32 v87, v133, v129, s53
    v_perm_b32 v91, v134, v130, s52
    v_perm_b32 v95, v134, v130, s53
    v_perm_b32 v99, v135, v131, s52
    v_perm_b32 v103, v135, v131, s53
    s_waitcnt vmcnt(6)
    v_perm_b32 v104, v140, v136, s52
    v_perm_b32 v108, v140, v136, s53
    v_perm_b32 v112, v141, v137, s52
    v_perm_b32 v116, v141, v137, s53
    v_perm_b32 v120, v142, v138, s52
    v_perm_b32 v124, v142, v138, s53
    v_perm_b32 v128, v143, v139, s52
    v_perm_b32 v132, v143, v139, s53
    s_waitcnt vmcnt(4)
    v_perm_b32 v105, v148, v144, s52
    v_perm_b32 v109, v148, v144, s53
    v_perm_b32 v113, v149, v145, s52
    v_perm_b32 v117, v149, v145, s53
    v_perm_b32 v121, v150, v146, s52
    v_perm_b32 v125, v150, v146, s53
    v_perm_b32 v129, v151, v147, s52
    v_perm_b32 v133, v151, v147, s53
    s_waitcnt vmcnt(2)
    v_perm_b32 v106, v156, v152, s52
    v_perm_b32 v110, v156, v152, s53
    v_perm_b32 v114, v157, v153, s52
    v_perm_b32 v118, v157, v153, s53
    v_perm_b32 v122, v158, v154, s52
    v_perm_b32 v126, v158, v154, s53
    v_perm_b32 v130, v159, v155, s52
    v_perm_b32 v134, v159, v155, s53
    s_waitcnt vmcnt(0)
    v_perm_b32 v107, v164, v160, s52
    v_perm_b32 v111, v164, v160, s53
    v_perm_b32 v115, v165, v161, s52
    v_perm_b32 v119, v165, v161, s53
    v_perm_b32 v123, v166, v162, s52
    v_perm_b32 v127, v166, v162, s53
    v_perm_b32 v131, v167, v163, s52
    v_perm_b32 v135, v167, v163, s53
    ds_read_b128 v[136:139], v7 offset:9216
    ds_read_b128 v[140:143], v7 offset:9280
    ds_read_b128 v[144:147], v7 offset:9344
    ds_read_b128 v[148:151], v7 offset:9408
    s_waitcnt lgkmcnt(3)
    v_mfma_f32_16x16x32_bf16 v[152:155], v[136:139], v[8:11], 0
    v_mfma_f32_16x16x32_bf16 v[156:159], v[136:139], v[12:15], 0
    v_mfma_f32_16x16x32_bf16 v[160:163], v[136:139], v[16:19], 0
    v_mfma_f32_16x16x32_bf16 v[164:167], v[136:139], v[20:23], 0
    s_waitcnt lgkmcnt(2)
    v_mfma_f32_16x16x32_bf16 v[152:155], v[140:143], v[40:43], v[152:155]
    v_mfma_f32_16x16x32_bf16 v[156:159], v[140:143], v[44:47], v[156:159]
    v_mfma_f32_16x16x32_bf16 v[160:163], v[140:143], v[48:51], v[160:163]
    v_mfma_f32_16x16x32_bf16 v[164:167], v[140:143], v[52:55], v[164:167]
    s_waitcnt lgkmcnt(1)
    v_mfma_f32_16x16x32_bf16 v[152:155], v[144:147], v[72:75], v[152:155]
    v_mfma_f32_16x16x32_bf16 v[156:159], v[144:147], v[76:79], v[156:159]
    v_mfma_f32_16x16x32_bf16 v[160:163], v[144:147], v[80:83], v[160:163]
    v_mfma_f32_16x16x32_bf16 v[164:167], v[144:147], v[84:87], v[164:167]
    s_waitcnt lgkmcnt(0)
    v_mfma_f32_16x16x32_bf16 v[152:155], v[148:151], v[104:107], v[152:155]
    v_mfma_f32_16x16x32_bf16 v[156:159], v[148:151], v[108:111], v[156:159]
    v_mfma_f32_16x16x32_bf16 v[160:163], v[148:151], v[112:115], v[160:163]
    v_mfma_f32_16x16x32_bf16 v[164:167], v[148:151], v[116:119], v[164:167]
    v_mfma_f32_16x16x32_bf16 v[8:11], v[136:139], v[24:27], 0
    v_mfma_f32_16x16x32_bf16 v[12:15], v[136:139], v[28:31], 0
    v_mfma_f32_16x16x32_bf16 v[16:19], v[136:139], v[32:35], 0
    v_mfma_f32_16x16x32_bf16 v[20:23], v[136:139], v[36:39], 0
    v_mfma_f32_16x16x32_bf16 v[8:11], v[140:143], v[56:59], v[8:11]
    v_mfma_f32_16x16x32_bf16 v[12:15], v[140:143], v[60:63], v[12:15]
    v_mfma_f32_16x16x32_bf16 v[16:19], v[140:143], v[64:67], v[16:19]
    v_mfma_f32_16x16x32_bf16 v[20:23], v[140:143], v[68:71], v[20:23]
    v_mfma_f32_16x16x32_bf16 v[8:11], v[144:147], v[88:91], v[8:11]
    v_mfma_f32_16x16x32_bf16 v[12:15], v[144:147], v[92:95], v[12:15]
    v_mfma_f32_16x16x32_bf16 v[16:19], v[144:147], v[96:99], v[16:19]
    v_mfma_f32_16x16x32_bf16 v[20:23], v[144:147], v[100:103], v[20:23]
    v_mfma_f32_16x16x32_bf16 v[8:11], v[148:151], v[120:123], v[8:11]
    v_mfma_f32_16x16x32_bf16 v[12:15], v[148:151], v[124:127], v[12:15]
    v_mfma_f32_16x16x32_bf16 v[16:19], v[148:151], v[128:131], v[16:19]
    v_mfma_f32_16x16x32_bf16 v[20:23], v[148:151], v[132:135], v[20:23]
    v_mov_b32 v5, s67
    v_perm_b32 v152, v152, v5, s86
    v_perm_b32 v153, v156, v5, s87
    v_perm_b32 v154, v160, v5, s86
    v_perm_b32 v155, v164, v5, s87
    buffer_store_dwordx4 v[152:155], v1, s[48:51], s63 offen offset:0 sc1
    s_nop 5
    v_perm_b32 v8, v8, v5, s86
    v_perm_b32 v9, v12, v5, s87
    v_perm_b32 v10, v16, v5, s86
    v_perm_b32 v11, v20, v5, s87
    buffer_store_dwordx4 v[8:11], v1, s[48:51], s63 offen offset:1024 sc1
    s_lshl_b32 s63, s58, 14
    s_lshl_b32 s60, s57, 8
    s_add_u32 s63, s63, s60
    s_add_u32 s63, s63, 1048576
    s_mov_b32 s64, 15
L_pq:
    s_bitcmp1_b32 s64, 0
    s_cbranch_scc0 L_pq_s0
    s_add_u32 s61, s63, 0
    buffer_load_dwordx4 v[40:43], v2, s[48:51], s61 offen sc1
L_pq_s0:
    s_bitcmp1_b32 s64, 1
    s_cbranch_scc0 L_pq_s1
    s_add_u32 s61, s63, 4096
    buffer_load_dwordx4 v[44:47], v2, s[48:51], s61 offen sc1
L_pq_s1:
    s_bitcmp1_b32 s64, 2
    s_cbranch_scc0 L_pq_s2
    s_add_u32 s61, s63, 8192
    buffer_load_dwordx4 v[48:51], v2, s[48:51], s61 offen sc1
L_pq_s2:
    s_bitcmp1_b32 s64, 3
    s_cbranch_scc0 L_pq_s3
    s_add_u32 s61, s63, 12288
    buffer_load_dwordx4 v[52:55], v2, s[48:51], s61 offen sc1
L_pq_s3:
    s_mov_b32 s64, 0
    s_waitcnt vmcnt(0)
    v_perm_b32 v32, v41, v40, s88
    v_perm_b32 v33, v43, v42, s88
    v_cmp_ne_u32 vcc, s67, v32
    v_cmp_ne_u32 s[68:69], s67, v33
    s_or_b64 s[68:69], s[68:69], vcc
    s_cselect_b32 s60, 1, 0
    s_or_b32 s64, s64, s60
    v_perm_b32 v32, v45, v44, s88
    v_perm_b32 v33, v47, v46, s88
    v_cmp_ne_u32 vcc, s67, v32
    v_cmp_ne_u32 s[68:69], s67, v33
    s_or_b64 s[68:69], s[68:69], vcc
    s_cselect_b32 s60, 2, 0
    s_or_b32 s64, s64, s60
    v_perm_b32 v32, v49, v48, s88
    v_perm_b32 v33, v51, v50, s88
    v_cmp_ne_u32 vcc, s67, v32
    v_cmp_ne_u32 s[68:69], s67, v33
    s_or_b64 s[68:69], s[68:69], vcc
    s_cselect_b32 s60, 4, 0
    s_or_b32 s64, s64, s60
    v_perm_b32 v32, v53, v52, s88
    v_perm_b32 v33, v55, v54, s88
    v_cmp_ne_u32 vcc, s67, v32
    v_cmp_ne_u32 s[68:69], s67, v33
    s_or_b64 s[68:69], s[68:69], vcc
    s_cselect_b32 s60, 8, 0
    s_or_b32 s64, s64, s60
    s_cmp_eq_u32 s64, 0
    s_cbranch_scc1 L_pq_ok
    s_sleep 1
    s_branch L_pq
L_pq_ok:
    v_and_b32 v40, 0xffffff00, v40
    v_and_b32 v41, 0xffffff00, v41
    v_and_b32 v42, 0xffffff00, v42
    v_and_b32 v43, 0xffffff00, v43
    v_and_b32 v44, 0xffffff00, v44
    v_and_b32 v45, 0xffffff00, v45
    v_and_b32 v46, 0xffffff00, v46
    v_and_b32 v47, 0xffffff00, v47
    v_and_b32 v48, 0xffffff00, v48
    v_and_b32 v49, 0xffffff00, v49
    v_and_b32 v50, 0xffffff00, v50
    v_and_b32 v51, 0xffffff00, v51
    v_and_b32 v52, 0xffffff00, v52
    v_and_b32 v53, 0xffffff00, v53
    v_and_b32 v54, 0xffffff00, v54
    v_and_b32 v55, 0xffffff00, v55
    v_add_f32 v40, v40, v44
    v_add_f32 v41, v41, v45
    v_add_f32 v42, v42, v46
    v_add_f32 v43, v43, v47
    v_add_f32 v40, v40, v48
    v_add_f32 v41, v41, v49
    v_add_f32 v42, v42, v50
    v_add_f32 v43, v43, v51
    v_add_f32 v40, v40, v52
    v_add_f32 v41, v41, v53
    v_add_f32 v42, v42, v54
    v_add_f32 v43, v43, v55
    v_mov_b32 v44, v40
    v_mov_b32 v45, v41
    v_mov_b32 v46, v42
    v_mov_b32 v47, v43
    v_permlane32_swap_b32 v40, v44
    v_permlane32_swap_b32 v41, v45
    v_permlane32_swap_b32 v42, v46
    v_permlane32_swap_b32 v43, v47
    v_add_f32 v40, v40, v44
    v_add_f32 v41, v41, v45
    v_add_f32 v42, v42, v46
    v_add_f32 v43, v43, v47
    v_cvt_pk_bf16_f32 v40, v40, v41
    v_cvt_pk_bf16_f32 v41, v42, v43
    ds_write_b64 v3, v[40:41] offset:8192
    s_waitcnt lgkmcnt(0)
    s_barrier
    v_lshrrev_b32 v8, 4, v0
    v_and_b32 v9, 15, v0
    v_mul_u32_u24 v6, 16384, v8
    v_lshl_add_u32 v6, v9, 4, v6
    s_mov_b32 s40, s12
    s_mov_b32 s41, s13
    s_lshl_b32 s62, s58, 18
    s_lshl_b32 s60, s65, 8
    s_add_u32 s62, s62, s60
    buffer_load_dwordx4 v[40:43], v6, s[40:43], s62 offen nt
    s_add_u32 s62, s62, 2048
    buffer_load_dwordx4 v[44:47], v6, s[40:43], s62 offen nt
    s_add_u32 s62, s62, 2048
    buffer_load_dwordx4 v[48:51], v6, s[40:43], s62 offen nt
    s_add_u32 s62, s62, 2048
    buffer_load_dwordx4 v[52:55], v6, s[40:43], s62 offen nt
    s_add_u32 s62, s62, 2048
    buffer_load_dwordx4 v[56:59], v6, s[40:43], s62 offen nt
    s_add_u32 s62, s62, 2048
    buffer_load_dwordx4 v[60:63], v6, s[40:43], s62 offen nt
    s_add_u32 s62, s62, 2048
    buffer_load_dwordx4 v[64:67], v6, s[40:43], s62 offen nt
    s_add_u32 s62, s62, 2048
    buffer_load_dwordx4 v[68:71], v6, s[40:43], s62 offen nt
    s_add_u32 s62, s62, 51200
    buffer_load_dwordx4 v[72:75], v6, s[40:43], s62 offen nt
    s_add_u32 s62, s62, 2048
    buffer_load_dwordx4 v[76:79], v6, s[40:43], s62 offen nt
    s_add_u32 s62, s62, 2048
    buffer_load_dwordx4 v[80:83], v6, s[40:43], s62 offen nt
    s_add_u32 s62, s62, 2048
    buffer_load_dwordx4 v[84:87], v6, s[40:43], s62 offen nt
    s_add_u32 s62, s62, 2048
    buffer_load_dwordx4 v[88:91], v6, s[40:43], s62 offen nt
    s_add_u32 s62, s62, 2048
    buffer_load_dwordx4 v[92:95], v6, s[40:43], s62 offen nt
    s_add_u32 s62, s62, 2048
    buffer_load_dwordx4 v[96:99], v6, s[40:43], s62 offen nt
    s_add_u32 s62, s62, 2048
    buffer_load_dwordx4 v[100:103], v6, s[40:43], s62 offen nt
    s_add_u32 s62, s62, 51200
    buffer_load_dwordx4 v[104:107], v6, s[40:43], s62 offen nt
    s_add_u32 s62, s62, 2048
    buffer_load_dwordx4 v[108:111], v6, s[40:43], s62 offen nt
    s_add_u32 s62, s62, 2048
    buffer_load_dwordx4 v[112:115], v6, s[40:43], s62 offen nt
    s_add_u32 s62, s62, 2048
    buffer_load_dwordx4 v[116:119], v6, s[40:43], s62 offen nt
    s_add_u32 s62, s62, 2048
    buffer_load_dwordx4 v[120:123], v6, s[40:43], s62 offen nt
    s_add_u32 s62, s62, 2048
    buffer_load_dwordx4 v[124:127], v6, s[40:43], s62 offen nt
    s_add_u32 s62, s62, 2048
    buffer_load_dwordx4 v[128:131], v6, s[40:43], s62 offen nt
    s_add_u32 s62, s62, 2048
    buffer_load_dwordx4 v[132:135], v6, s[40:43], s62 offen nt
    s_add_u32 s62, s62, 51200
    buffer_load_dwordx4 v[136:139], v6, s[40:43], s62 offen nt
    s_add_u32 s62, s62, 2048
    buffer_load_dwordx4 v[140:143], v6, s[40:43], s62 offen nt
    s_add_u32 s62, s62, 2048
    buffer_load_dwordx4 v[144:147], v6, s[40:43], s62 offen nt
    s_add_u32 s62, s62, 2048
    buffer_load_dwordx4 v[148:151], v6, s[40:43], s62 offen nt
    s_add_u32 s62, s62, 2048
    buffer_load_dwordx4 v[152:155], v6, s[40:43], s62 offen nt
    s_add_u32 s62, s62, 2048
    buffer_load_dwordx4 v[156:159], v6, s[40:43], s62 offen nt
    s_add_u32 s62, s62, 2048
    buffer_load_dwordx4 v[160:163], v6, s[40:43], s62 offen nt
    s_add_u32 s62, s62, 2048
    buffer_load_dwordx4 v[164:167], v6, s[40:43], s62 offen nt
    v_lshlrev_b32 v2, 2, v0
    s_waitcnt vmcnt(30)
    v_perm_b32 v8, v44, v40, s52
    v_perm_b32 v12, v44, v40, s53
    v_perm_b32 v16, v45, v41, s52
    v_perm_b32 v20, v45, v41, s53
    v_perm_b32 v24, v46, v42, s52
    v_perm_b32 v28, v46, v42, s53
    v_perm_b32 v32, v47, v43, s52
    v_perm_b32 v36, v47, v43, s53
    s_waitcnt vmcnt(28)
    v_perm_b32 v9, v52, v48, s52
    v_perm_b32 v13, v52, v48, s53
    v_perm_b32 v17, v53, v49, s52
    v_perm_b32 v21, v53, v49, s53
    v_perm_b32 v25, v54, v50, s52
    v_perm_b32 v29, v54, v50, s53
    v_perm_b32 v33, v55, v51, s52
    v_perm_b32 v37, v55, v51, s53
    s_waitcnt vmcnt(26)
    v_perm_b32 v10, v60, v56, s52
    v_perm_b32 v14, v60, v56, s53
    v_perm_b32 v18, v61, v57, s52
    v_perm_b32 v22, v61, v57, s53
    v_perm_b32 v26, v62, v58, s52
    v_perm_b32 v30, v62, v58, s53
    v_perm_b32 v34, v63, v59, s52
    v_perm_b32 v38, v63, v59, s53
    s_waitcnt vmcnt(24)
    v_perm_b32 v11, v68, v64, s52
    v_perm_b32 v15, v68, v64, s53
    v_perm_b32 v19, v69, v65, s52
    v_perm_b32 v23, v69, v65, s53
    v_perm_b32 v27, v70, v66, s52
    v_perm_b32 v31, v70, v66, s53
    v_perm_b32 v35, v71, v67, s52
    v_perm_b32 v39, v71, v67, s53
    s_waitcnt vmcnt(22)
    v_perm_b32 v40, v76, v72, s52
    v_perm_b32 v44, v76, v72, s53
    v_perm_b32 v48, v77, v73, s52
    v_perm_b32 v52, v77, v73, s53
    v_perm_b32 v56, v78, v74, s52
    v_perm_b32 v60, v78, v74, s53
    v_perm_b32 v64, v79, v75, s52
    v_perm_b32 v68, v79, v75, s53
    s_waitcnt vmcnt(20)
    v_perm_b32 v41, v84, v80, s52
    v_perm_b32 v45, v84, v80, s53
    v_perm_b32 v49, v85, v81, s52
    v_perm_b32 v53, v85, v81, s53
    v_perm_b32 v57, v86, v82, s52
    v_perm_b32 v61, v86, v82, s53
    v_perm_b32 v65, v87, v83, s52
    v_perm_b32 v69, v87, v83, s53
    s_waitcnt vmcnt(18)
    v_perm_b32 v42, v92, v88, s52
    v_perm_b32 v46, v92, v88, s53
    v_perm_b32 v50, v93, v89, s52
    v_perm_b32 v54, v93, v89, s53
    v_perm_b32 v58, v94, v90, s52
    v_perm_b32 v62, v94, v90, s53
    v_perm_b32 v66, v95, v91, s52
    v_perm_b32 v70, v95, v91, s53
    s_waitcnt vmcnt(16)
    v_perm_b32 v43, v100, v96, s52
    v_perm_b32 v47, v100, v96, s53
    v_perm_b32 v51, v101, v97, s52
    v_perm_b32 v55, v101, v97, s53
    v_perm_b32 v59, v102, v98, s52
    v_perm_b32 v63, v102, v98, s53
    v_perm_b32 v67, v103, v99, s52
    v_perm_b32 v71, v103, v99, s53
    s_waitcnt vmcnt(14)
    v_perm_b32 v72, v108, v104, s52
    v_perm_b32 v76, v108, v104, s53
    v_perm_b32 v80, v109, v105, s52
    v_perm_b32 v84, v109, v105, s53
    v_perm_b32 v88, v110, v106, s52
    v_perm_b32 v92, v110, v106, s53
    v_perm_b32 v96, v111, v107, s52
    v_perm_b32 v100, v111, v107, s53
    s_waitcnt vmcnt(12)
    v_perm_b32 v73, v116, v112, s52
    v_perm_b32 v77, v116, v112, s53
    v_perm_b32 v81, v117, v113, s52
    v_perm_b32 v85, v117, v113, s53
    v_perm_b32 v89, v118, v114, s52
    v_perm_b32 v93, v118, v114, s53
    v_perm_b32 v97, v119, v115, s52
    v_perm_b32 v101, v119, v115, s53
    s_waitcnt vmcnt(10)
    v_perm_b32 v74, v124, v120, s52
    v_perm_b32 v78, v124, v120, s53
    v_perm_b32 v82, v125, v121, s52
    v_perm_b32 v86, v125, v121, s53
    v_perm_b32 v90, v126, v122, s52
    v_perm_b32 v94, v126, v122, s53
    v_perm_b32 v98, v127, v123, s52
    v_perm_b32 v102, v127, v123, s53
    s_waitcnt vmcnt(8)
    v_perm_b32 v75, v132, v128, s52
    v_perm_b32 v79, v132, v128, s53
    v_perm_b32 v83, v133, v129, s52
    v_perm_b32 v87, v133, v129, s53
    v_perm_b32 v91, v134, v130, s52
    v_perm_b32 v95, v134, v130, s53
    v_perm_b32 v99, v135, v131, s52
    v_perm_b32 v103, v135, v131, s53
    s_waitcnt vmcnt(6)
    v_perm_b32 v104, v140, v136, s52
    v_perm_b32 v108, v140, v136, s53
    v_perm_b32 v112, v141, v137, s52
    v_perm_b32 v116, v141, v137, s53
    v_perm_b32 v120, v142, v138, s52
    v_perm_b32 v124, v142, v138, s53
    v_perm_b32 v128, v143, v139, s52
    v_perm_b32 v132, v143, v139, s53
    s_waitcnt vmcnt(4)
    v_perm_b32 v105, v148, v144, s52
    v_perm_b32 v109, v148, v144, s53
    v_perm_b32 v113, v149, v145, s52
    v_perm_b32 v117, v149, v145, s53
    v_perm_b32 v121, v150, v146, s52
    v_perm_b32 v125, v150, v146, s53
    v_perm_b32 v129, v151, v147, s52
    v_perm_b32 v133, v151, v147, s53
    s_waitcnt vmcnt(2)
    v_perm_b32 v106, v156, v152, s52
    v_perm_b32 v110, v156, v152, s53
    v_perm_b32 v114, v157, v153, s52
    v_perm_b32 v118, v157, v153, s53
    v_perm_b32 v122, v158, v154, s52
    v_perm_b32 v126, v158, v154, s53
    v_perm_b32 v130, v159, v155, s52
    v_perm_b32 v134, v159, v155, s53
    s_waitcnt vmcnt(0)
    v_perm_b32 v107, v164, v160, s52
    v_perm_b32 v111, v164, v160, s53
    v_perm_b32 v115, v165, v161, s52
    v_perm_b32 v119, v165, v161, s53
    v_perm_b32 v123, v166, v162, s52
    v_perm_b32 v127, v166, v162, s53
    v_perm_b32 v131, v167, v163, s52
    v_perm_b32 v135, v167, v163, s53
    s_lshl_b32 s63, s58, 13
    s_add_u32 s63, s63, 4096
    s_barrier
    s_mov_b32 s64, 255
L_pp:
    s_bitcmp1_b32 s64, 0
    s_cbranch_scc0 L_pp_s0
    s_add_u32 s61, s63, 0
    buffer_load_dwordx4 v[136:139], v1, s[48:51], s61 offen sc1
L_pp_s0:
    s_bitcmp1_b32 s64, 1
    s_cbranch_scc0 L_pp_s1
    s_add_u32 s61, s63, 1024
    buffer_load_dwordx4 v[140:143], v1, s[48:51], s61 offen sc1
L_pp_s1:
    s_bitcmp1_b32 s64, 2
    s_cbranch_scc0 L_pp_s2
    s_add_u32 s61, s63, 2048
    buffer_load_dwordx4 v[144:147], v1, s[48:51], s61 offen sc1
L_pp_s2:
    s_bitcmp1_b32 s64, 3
    s_cbranch_scc0 L_pp_s3
    s_add_u32 s61, s63, 3072
    buffer_load_dwordx4 v[148:151], v1, s[48:51], s61 offen sc1
L_pp_s3:
    s_bitcmp1_b32 s64, 4
    s_cbranch_scc0 L_pp_s4
    s_add_u32 s61, s63, 4096
    buffer_load_dwordx4 v[152:155], v1, s[48:51], s61 offen sc1
L_pp_s4:
    s_bitcmp1_b32 s64, 5
    s_cbranch_scc0 L_pp_s5
    s_add_u32 s61, s63, 5120
    buffer_load_dwordx4 v[156:159], v1, s[48:51], s61 offen sc1
L_pp_s5:
    s_bitcmp1_b32 s64, 6
    s_cbranch_scc0 L_pp_s6
    s_add_u32 s61, s63, 6144
    buffer_load_dwordx4 v[160:163], v1, s[48:51], s61 offen sc1
L_pp_s6:
    s_bitcmp1_b32 s64, 7
    s_cbranch_scc0 L_pp_s7
    s_add_u32 s61, s63, 7168
    buffer_load_dwordx4 v[164:167], v1, s[48:51], s61 offen sc1
L_pp_s7:
    s_mov_b32 s64, 0
    s_waitcnt vmcnt(0)
    v_cmp_ne_u16 vcc, s67, v138
    v_cmp_ne_u16 s[68:69], s67, v139
    s_or_b64 s[68:69], s[68:69], vcc
    s_cselect_b32 s60, 1, 0
    s_or_b32 s64, s64, s60
    v_cmp_ne_u16 vcc, s67, v142
    v_cmp_ne_u16 s[68:69], s67, v143
    s_or_b64 s[68:69], s[68:69], vcc
    s_cselect_b32 s60, 2, 0
    s_or_b32 s64, s64, s60
    v_cmp_ne_u16 vcc, s67, v146
    v_cmp_ne_u16 s[68:69], s67, v147
    s_or_b64 s[68:69], s[68:69], vcc
    s_cselect_b32 s60, 4, 0
    s_or_b32 s64, s64, s60
    v_cmp_ne_u16 vcc, s67, v150
    v_cmp_ne_u16 s[68:69], s67, v151
    s_or_b64 s[68:69], s[68:69], vcc
    s_cselect_b32 s60, 8, 0
    s_or_b32 s64, s64, s60
    v_cmp_ne_u16 vcc, s67, v154
    v_cmp_ne_u16 s[68:69], s67, v155
    s_or_b64 s[68:69], s[68:69], vcc
    s_cselect_b32 s60, 16, 0
    s_or_b32 s64, s64, s60
    v_cmp_ne_u16 vcc, s67, v158
    v_cmp_ne_u16 s[68:69], s67, v159
    s_or_b64 s[68:69], s[68:69], vcc
    s_cselect_b32 s60, 32, 0
    s_or_b32 s64, s64, s60
    v_cmp_ne_u16 vcc, s67, v162
    v_cmp_ne_u16 s[68:69], s67, v163
    s_or_b64 s[68:69], s[68:69], vcc
    s_cselect_b32 s60, 64, 0
    s_or_b32 s64, s64, s60
    v_cmp_ne_u16 vcc, s67, v166
    v_cmp_ne_u16 s[68:69], s67, v167
    s_or_b64 s[68:69], s[68:69], vcc
    s_cselect_b32 s60, 128, 0
    s_or_b32 s64, s64, s60
    s_cmp_eq_u32 s64, 0
    s_cbranch_scc1 L_pp_ok
    s_sleep 1
    s_branch L_pp
L_pp_ok:
    s_barrier
    v_perm_b32 v138, v138, v139, s53
    v_perm_b32 v142, v142, v143, s53
    v_perm_b32 v146, v146, v147, s53
    v_perm_b32 v150, v150, v151, s53
    v_perm_b32 v154, v154, v155, s53
    v_perm_b32 v158, v158, v159, s53
    v_perm_b32 v162, v162, v163, s53
    v_perm_b32 v166, v166, v167, s53
    v_sub_f32 v139, v138, v142
    v_sub_f32 v147, v146, v150
    v_sub_f32 v155, v154, v158
    v_sub_f32 v163, v162, v166
    v_exp_f32 v139, v139
    v_exp_f32 v147, v147
    v_exp_f32 v155, v155
    v_exp_f32 v163, v163
    v_sub_f32 v140, v140, v136
    v_sub_f32 v141, v141, v137
    v_sub_f32 v148, v148, v144
    v_sub_f32 v149, v149, v145
    v_sub_f32 v156, v156, v152
    v_sub_f32 v157, v157, v153
    v_sub_f32 v164, v164, v160
    v_sub_f32 v165, v165, v161
    v_add_f32 v139, 1.0, v139
    v_add_f32 v147, 1.0, v147
    v_add_f32 v155, 1.0, v155
    v_add_f32 v163, 1.0, v163
    v_rcp_f32 v139, v139
    v_rcp_f32 v147, v147
    v_rcp_f32 v155, v155
    v_rcp_f32 v163, v163
    s_lshl_b32 s63, s58, 3
    s_add_u32 s63, s63, s65
    s_lshl_b32 s63, s63, 11
    s_add_u32 s63, s63, 5242880
    v_fma_f32 v136, v139, v140, v136
    v_fma_f32 v137, v139, v141, v137
    v_cvt_pk_bf16_f32 v138, v136, v137
    ds_write_b32 v2, v138 offset:9216
    v_fma_f32 v144, v147, v148, v144
    v_fma_f32 v145, v147, v149, v145
    v_cvt_pk_bf16_f32 v146, v144, v145
    ds_write_b32 v2, v146 offset:9472
    v_fma_f32 v152, v155, v156, v152
    v_fma_f32 v153, v155, v157, v153
    v_cvt_pk_bf16_f32 v154, v152, v153
    ds_write_b32 v2, v154 offset:9728
    v_fma_f32 v160, v163, v164, v160
    v_fma_f32 v161, v163, v165, v161
    v_cvt_pk_bf16_f32 v162, v160, v161
    ds_write_b32 v2, v162 offset:9984
    s_waitcnt lgkmcnt(0)
    ds_read_b128 v[136:139], v7 offset:9216
    ds_read_b128 v[140:143], v7 offset:9280
    ds_read_b128 v[144:147], v7 offset:9344
    ds_read_b128 v[148:151], v7 offset:9408
    s_waitcnt lgkmcnt(3)
    v_mfma_f32_16x16x32_bf16 v[152:155], v[136:139], v[8:11], 0
    v_mfma_f32_16x16x32_bf16 v[156:159], v[136:139], v[12:15], 0
    v_mfma_f32_16x16x32_bf16 v[160:163], v[136:139], v[16:19], 0
    v_mfma_f32_16x16x32_bf16 v[164:167], v[136:139], v[20:23], 0
    s_waitcnt lgkmcnt(2)
    v_mfma_f32_16x16x32_bf16 v[152:155], v[140:143], v[40:43], v[152:155]
    v_mfma_f32_16x16x32_bf16 v[156:159], v[140:143], v[44:47], v[156:159]
    v_mfma_f32_16x16x32_bf16 v[160:163], v[140:143], v[48:51], v[160:163]
    v_mfma_f32_16x16x32_bf16 v[164:167], v[140:143], v[52:55], v[164:167]
    s_waitcnt lgkmcnt(1)
    v_mfma_f32_16x16x32_bf16 v[152:155], v[144:147], v[72:75], v[152:155]
    v_mfma_f32_16x16x32_bf16 v[156:159], v[144:147], v[76:79], v[156:159]
    v_mfma_f32_16x16x32_bf16 v[160:163], v[144:147], v[80:83], v[160:163]
    v_mfma_f32_16x16x32_bf16 v[164:167], v[144:147], v[84:87], v[164:167]
    s_waitcnt lgkmcnt(0)
    v_mfma_f32_16x16x32_bf16 v[152:155], v[148:151], v[104:107], v[152:155]
    v_mfma_f32_16x16x32_bf16 v[156:159], v[148:151], v[108:111], v[156:159]
    v_mfma_f32_16x16x32_bf16 v[160:163], v[148:151], v[112:115], v[160:163]
    v_mfma_f32_16x16x32_bf16 v[164:167], v[148:151], v[116:119], v[164:167]
    v_mfma_f32_16x16x32_bf16 v[8:11], v[136:139], v[24:27], 0
    v_mfma_f32_16x16x32_bf16 v[12:15], v[136:139], v[28:31], 0
    v_mfma_f32_16x16x32_bf16 v[16:19], v[136:139], v[32:35], 0
    v_mfma_f32_16x16x32_bf16 v[20:23], v[136:139], v[36:39], 0
    v_mfma_f32_16x16x32_bf16 v[8:11], v[140:143], v[56:59], v[8:11]
    v_mfma_f32_16x16x32_bf16 v[12:15], v[140:143], v[60:63], v[12:15]
    v_mfma_f32_16x16x32_bf16 v[16:19], v[140:143], v[64:67], v[16:19]
    v_mfma_f32_16x16x32_bf16 v[20:23], v[140:143], v[68:71], v[20:23]
    v_mfma_f32_16x16x32_bf16 v[8:11], v[144:147], v[88:91], v[8:11]
    v_mfma_f32_16x16x32_bf16 v[12:15], v[144:147], v[92:95], v[12:15]
    v_mfma_f32_16x16x32_bf16 v[16:19], v[144:147], v[96:99], v[16:19]
    v_mfma_f32_16x16x32_bf16 v[20:23], v[144:147], v[100:103], v[20:23]
    v_mfma_f32_16x16x32_bf16 v[8:11], v[148:151], v[120:123], v[8:11]
    v_mfma_f32_16x16x32_bf16 v[12:15], v[148:151], v[124:127], v[12:15]
    v_mfma_f32_16x16x32_bf16 v[16:19], v[148:151], v[128:131], v[16:19]
    v_mfma_f32_16x16x32_bf16 v[20:23], v[148:151], v[132:135], v[20:23]
    v_mov_b32 v5, s67
    v_perm_b32 v152, v152, v5, s86
    v_perm_b32 v153, v156, v5, s87
    v_perm_b32 v154, v160, v5, s86
    v_perm_b32 v155, v164, v5, s87
    buffer_store_dwordx4 v[152:155], v1, s[48:51], s63 offen offset:0 sc1
    s_nop 5
    v_perm_b32 v8, v8, v5, s86
    v_perm_b32 v9, v12, v5, s87
    v_perm_b32 v10, v16, v5, s86
    v_perm_b32 v11, v20, v5, s87
    buffer_store_dwordx4 v[8:11], v1, s[48:51], s63 offen offset:1024 sc1
    s_endpgm
L_aux123:
    s_cmp_lt_u32 s58, 28
    s_cbranch_scc1 L_ffn
    s_cmp_lg_u32 s3, 3
    s_cbranch_scc1 L_end
    s_waitcnt lgkmcnt(0)
    s_load_dword s66, s[30:31], 0
    s_mov_b32 s48, s30
    s_mov_b32 s49, s31
    s_mov_b32 s44, s4
    s_mov_b32 s45, s5
    s_waitcnt lgkmcnt(0)
    s_mul_i32 s66, s66, 0x19660d
    s_add_u32 s66, s66, 0x3c6ef35f
    s_and_b32 s67, s66, 0xffff
    s_barrier
    s_branch L_red
L_ffn:
    s_mov_b32 s42, 7340032
    s_cmp_lg_u32 s3, 1
    s_cbranch_scc1 L_gu
    v_lshrrev_b32 v8, 4, v0
    v_and_b32 v9, 15, v0
    v_mul_u32_u24 v6, 16384, v8
    v_lshl_add_u32 v6, v9, 4, v6
    s_lshl_b32 s62, s58, 18
    s_lshl_b32 s60, s65, 8
    s_add_u32 s62, s62, s60
    s_waitcnt lgkmcnt(0)
    s_mov_b32 s40, s22
    s_mov_b32 s41, s23
    s_load_dword s66, s[30:31], 0
    s_mov_b32 s48, s30
    s_mov_b32 s49, s31
    buffer_load_dwordx4 v[40:43], v6, s[40:43], s62 offen nt
    s_add_u32 s62, s62, 2048
    buffer_load_dwordx4 v[44:47], v6, s[40:43], s62 offen nt
    s_add_u32 s62, s62, 2048
    buffer_load_dwordx4 v[48:51], v6, s[40:43], s62 offen nt
    s_add_u32 s62, s62, 2048
    buffer_load_dwordx4 v[52:55], v6, s[40:43], s62 offen nt
    s_add_u32 s62, s62, 2048
    buffer_load_dwordx4 v[56:59], v6, s[40:43], s62 offen nt
    s_add_u32 s62, s62, 2048
    buffer_load_dwordx4 v[60:63], v6, s[40:43], s62 offen nt
    s_add_u32 s62, s62, 2048
    buffer_load_dwordx4 v[64:67], v6, s[40:43], s62 offen nt
    s_add_u32 s62, s62, 2048
    buffer_load_dwordx4 v[68:71], v6, s[40:43], s62 offen nt
    s_add_u32 s62, s62, 51200
    buffer_load_dwordx4 v[72:75], v6, s[40:43], s62 offen nt
    s_add_u32 s62, s62, 2048
    buffer_load_dwordx4 v[76:79], v6, s[40:43], s62 offen nt
    s_add_u32 s62, s62, 2048
    buffer_load_dwordx4 v[80:83], v6, s[40:43], s62 offen nt
    s_add_u32 s62, s62, 2048
    buffer_load_dwordx4 v[84:87], v6, s[40:43], s62 offen nt
    s_add_u32 s62, s62, 2048
    buffer_load_dwordx4 v[88:91], v6, s[40:43], s62 offen nt
    s_add_u32 s62, s62, 2048
    buffer_load_dwordx4 v[92:95], v6, s[40:43], s62 offen nt
    s_add_u32 s62, s62, 2048
    buffer_load_dwordx4 v[96:99], v6, s[40:43], s62 offen nt
    s_add_u32 s62, s62, 2048
    buffer_load_dwordx4 v[100:103], v6, s[40:43], s62 offen nt
    s_add_u32 s62, s62, 51200
    buffer_load_dwordx4 v[104:107], v6, s[40:43], s62 offen nt
    s_add_u32 s62, s62, 2048
    buffer_load_dwordx4 v[108:111], v6, s[40:43], s62 offen nt
    s_add_u32 s62, s62, 2048
    buffer_load_dwordx4 v[112:115], v6, s[40:43], s62 offen nt
    s_add_u32 s62, s62, 2048
    buffer_load_dwordx4 v[116:119], v6, s[40:43], s62 offen nt
    s_add_u32 s62, s62, 2048
    buffer_load_dwordx4 v[120:123], v6, s[40:43], s62 offen nt
    s_add_u32 s62, s62, 2048
    buffer_load_dwordx4 v[124:127], v6, s[40:43], s62 offen nt
    s_add_u32 s62, s62, 2048
    buffer_load_dwordx4 v[128:131], v6, s[40:43], s62 offen nt
    s_add_u32 s62, s62, 2048
    buffer_load_dwordx4 v[132:135], v6, s[40:43], s62 offen nt
    s_add_u32 s62, s62, 51200
    buffer_load_dwordx4 v[136:139], v6, s[40:43], s62 offen nt
    s_add_u32 s62, s62, 2048
    buffer_load_dwordx4 v[140:143], v6, s[40:43], s62 offen nt
    s_add_u32 s62, s62, 2048
    buffer_load_dwordx4 v[144:147], v6, s[40:43], s62 offen nt
    s_add_u32 s62, s62, 2048
    buffer_load_dwordx4 v[148:151], v6, s[40:43], s62 offen nt
    s_add_u32 s62, s62, 2048
    buffer_load_dwordx4 v[152:155], v6, s[40:43], s62 offen nt
    s_add_u32 s62, s62, 2048
    buffer_load_dwordx4 v[156:159], v6, s[40:43], s62 offen nt
    s_add_u32 s62, s62, 2048
    buffer_load_dwordx4 v[160:163], v6, s[40:43], s62 offen nt
    s_add_u32 s62, s62, 2048
    buffer_load_dwordx4 v[164:167], v6, s[40:43], s62 offen nt
    v_bfe_u32 v7, v0, 2, 2
    v_lshlrev_b32 v7, 8, v7
    v_lshrrev_b32 v11, 4, v0
    v_lshl_add_u32 v7, v11, 4, v7
    v_mov_b32 v2, 8452
    v_mov_b32 v3, 0
    ds_write_b32 v2, v3
    ds_write_b32 v2, v3 offset:4
    ds_write_b32 v2, v3 offset:8
    s_waitcnt lgkmcnt(0)
    s_barrier
    s_mul_i32 s66, s66, 0x19660d
    s_add_u32 s66, s66, 0x3c6ef35f
    s_and_b32 s67, s66, 0xffff
    v_lshlrev_b32 v2, 3, v0
    s_waitcnt vmcnt(30)
    v_perm_b32 v8, v44, v40, s52
    v_perm_b32 v12, v44, v40, s53
    v_perm_b32 v16, v45, v41, s52
    v_perm_b32 v20, v45, v41, s53
    v_perm_b32 v24, v46, v42, s52
    v_perm_b32 v28, v46, v42, s53
    v_perm_b32 v32, v47, v43, s52
    v_perm_b32 v36, v47, v43, s53
    s_waitcnt vmcnt(28)
    v_perm_b32 v9, v52, v48, s52
    v_perm_b32 v13, v52, v48, s53
    v_perm_b32 v17, v53, v49, s52
    v_perm_b32 v21, v53, v49, s53
    v_perm_b32 v25, v54, v50, s52
    v_perm_b32 v29, v54, v50, s53
    v_perm_b32 v33, v55, v51, s52
    v_perm_b32 v37, v55, v51, s53
    s_waitcnt vmcnt(26)
    v_perm_b32 v10, v60, v56, s52
    v_perm_b32 v14, v60, v56, s53
    v_perm_b32 v18, v61, v57, s52
    v_perm_b32 v22, v61, v57, s53
    v_perm_b32 v26, v62, v58, s52
    v_perm_b32 v30, v62, v58, s53
    v_perm_b32 v34, v63, v59, s52
    v_perm_b32 v38, v63, v59, s53
    s_waitcnt vmcnt(24)
    v_perm_b32 v11, v68, v64, s52
    v_perm_b32 v15, v68, v64, s53
    v_perm_b32 v19, v69, v65, s52
    v_perm_b32 v23, v69, v65, s53
    v_perm_b32 v27, v70, v66, s52
    v_perm_b32 v31, v70, v66, s53
    v_perm_b32 v35, v71, v67, s52
    v_perm_b32 v39, v71, v67, s53
    s_waitcnt vmcnt(22)
    v_perm_b32 v40, v76, v72, s52
    v_perm_b32 v44, v76, v72, s53
    v_perm_b32 v48, v77, v73, s52
    v_perm_b32 v52, v77, v73, s53
    v_perm_b32 v56, v78, v74, s52
    v_perm_b32 v60, v78, v74, s53
    v_perm_b32 v64, v79, v75, s52
    v_perm_b32 v68, v79, v75, s53
    s_waitcnt vmcnt(20)
    v_perm_b32 v41, v84, v80, s52
    v_perm_b32 v45, v84, v80, s53
    v_perm_b32 v49, v85, v81, s52
    v_perm_b32 v53, v85, v81, s53
    v_perm_b32 v57, v86, v82, s52
    v_perm_b32 v61, v86, v82, s53
    v_perm_b32 v65, v87, v83, s52
    v_perm_b32 v69, v87, v83, s53
    s_waitcnt vmcnt(18)
    v_perm_b32 v42, v92, v88, s52
    v_perm_b32 v46, v92, v88, s53
    v_perm_b32 v50, v93, v89, s52
    v_perm_b32 v54, v93, v89, s53
    v_perm_b32 v58, v94, v90, s52
    v_perm_b32 v62, v94, v90, s53
    v_perm_b32 v66, v95, v91, s52
    v_perm_b32 v70, v95, v91, s53
    s_waitcnt vmcnt(16)
    v_perm_b32 v43, v100, v96, s52
    v_perm_b32 v47, v100, v96, s53
    v_perm_b32 v51, v101, v97, s52
    v_perm_b32 v55, v101, v97, s53
    v_perm_b32 v59, v102, v98, s52
    v_perm_b32 v63, v102, v98, s53
    v_perm_b32 v67, v103, v99, s52
    v_perm_b32 v71, v103, v99, s53
    s_waitcnt vmcnt(14)
    v_perm_b32 v72, v108, v104, s52
    v_perm_b32 v76, v108, v104, s53
    v_perm_b32 v80, v109, v105, s52
    v_perm_b32 v84, v109, v105, s53
    v_perm_b32 v88, v110, v106, s52
    v_perm_b32 v92, v110, v106, s53
    v_perm_b32 v96, v111, v107, s52
    v_perm_b32 v100, v111, v107, s53
    s_waitcnt vmcnt(12)
    v_perm_b32 v73, v116, v112, s52
    v_perm_b32 v77, v116, v112, s53
    v_perm_b32 v81, v117, v113, s52
    v_perm_b32 v85, v117, v113, s53
    v_perm_b32 v89, v118, v114, s52
    v_perm_b32 v93, v118, v114, s53
    v_perm_b32 v97, v119, v115, s52
    v_perm_b32 v101, v119, v115, s53
    s_waitcnt vmcnt(10)
    v_perm_b32 v74, v124, v120, s52
    v_perm_b32 v78, v124, v120, s53
    v_perm_b32 v82, v125, v121, s52
    v_perm_b32 v86, v125, v121, s53
    v_perm_b32 v90, v126, v122, s52
    v_perm_b32 v94, v126, v122, s53
    v_perm_b32 v98, v127, v123, s52
    v_perm_b32 v102, v127, v123, s53
    s_waitcnt vmcnt(8)
    v_perm_b32 v75, v132, v128, s52
    v_perm_b32 v79, v132, v128, s53
    v_perm_b32 v83, v133, v129, s52
    v_perm_b32 v87, v133, v129, s53
    v_perm_b32 v91, v134, v130, s52
    v_perm_b32 v95, v134, v130, s53
    v_perm_b32 v99, v135, v131, s52
    v_perm_b32 v103, v135, v131, s53
    s_waitcnt vmcnt(6)
    v_perm_b32 v104, v140, v136, s52
    v_perm_b32 v108, v140, v136, s53
    v_perm_b32 v112, v141, v137, s52
    v_perm_b32 v116, v141, v137, s53
    v_perm_b32 v120, v142, v138, s52
    v_perm_b32 v124, v142, v138, s53
    v_perm_b32 v128, v143, v139, s52
    v_perm_b32 v132, v143, v139, s53
    s_waitcnt vmcnt(4)
    v_perm_b32 v105, v148, v144, s52
    v_perm_b32 v109, v148, v144, s53
    v_perm_b32 v113, v149, v145, s52
    v_perm_b32 v117, v149, v145, s53
    v_perm_b32 v121, v150, v146, s52
    v_perm_b32 v125, v150, v146, s53
    v_perm_b32 v129, v151, v147, s52
    v_perm_b32 v133, v151, v147, s53
    s_waitcnt vmcnt(2)
    v_perm_b32 v106, v156, v152, s52
    v_perm_b32 v110, v156, v152, s53
    v_perm_b32 v114, v157, v153, s52
    v_perm_b32 v118, v157, v153, s53
    v_perm_b32 v122, v158, v154, s52
    v_perm_b32 v126, v158, v154, s53
    v_perm_b32 v130, v159, v155, s52
    v_perm_b32 v134, v159, v155, s53
    s_waitcnt vmcnt(0)
    v_perm_b32 v107, v164, v160, s52
    v_perm_b32 v111, v164, v160, s53
    v_perm_b32 v115, v165, v161, s52
    v_perm_b32 v119, v165, v161, s53
    v_perm_b32 v123, v166, v162, s52
    v_perm_b32 v127, v166, v162, s53
    v_perm_b32 v131, v167, v163, s52
    v_perm_b32 v135, v167, v163, s53
    s_lshl_b32 s63, s58, 11
    s_add_u32 s63, s63, 327680
    v_mov_b32 v3, 8452
L_wf1:
    ds_read_b32 v4, v3
    s_waitcnt lgkmcnt(0)
    v_readfirstlane_b32 s60, v4
    s_cmp_lg_u32 s60, 0
    s_cbranch_scc1 L_wf1_ok
    s_sleep 32
    s_branch L_wf1
L_wf1_ok:
    s_mov_b32 s64, 3
L_ph:
    s_bitcmp1_b32 s64, 0
    s_cbranch_scc0 L_ph_s0
    s_add_u32 s61, s63, 0
    buffer_load_dwordx4 v[136:139], v1, s[48:51], s61 offen sc1
L_ph_s0:
    s_bitcmp1_b32 s64, 1
    s_cbranch_scc0 L_ph_s1
    s_add_u32 s61, s63, 1024
    buffer_load_dwordx4 v[140:143], v1, s[48:51], s61 offen sc1
L_ph_s1:
    s_mov_b32 s64, 0
    s_waitcnt vmcnt(0)
    v_cmp_ne_u32 vcc, s66, v137
    v_cmp_ne_u32 s[68:69], s66, v139
    s_or_b64 s[68:69], s[68:69], vcc
    s_cselect_b32 s60, 1, 0
    s_or_b32 s64, s64, s60
    v_cmp_ne_u32 vcc, s66, v141
    v_cmp_ne_u32 s[68:69], s66, v143
    s_or_b64 s[68:69], s[68:69], vcc
    s_cselect_b32 s60, 2, 0
    s_or_b32 s64, s64, s60
    s_cmp_eq_u32 s64, 0
    s_cbranch_scc1 L_ph_ok
    s_sleep 16
    s_branch L_ph
L_ph_ok:
    v_mov_b32 v137, v138
    ds_write_b64 v2, v[136:137] offset:10240
    v_mov_b32 v141, v142
    ds_write_b64 v2, v[140:141] offset:10752
    s_lshl_b32 s63, s58, 3
    s_add_u32 s63, s63, s65
    s_lshl_b32 s63, s63, 11
    s_add_u32 s63, s63, 4194304
    s_waitcnt lgkmcnt(0)
    ds_read_b128 v[136:139], v7 offset:10240
    ds_read_b128 v[140:143], v7 offset:10304
    ds_read_b128 v[144:147], v7 offset:10368
    ds_read_b128 v[148:151], v7 offset:10432
    s_waitcnt lgkmcnt(3)
    v_mfma_f32_16x16x32_bf16 v[152:155], v[136:139], v[8:11], 0
    v_mfma_f32_16x16x32_bf16 v[156:159], v[136:139], v[12:15], 0
    v_mfma_f32_16x16x32_bf16 v[160:163], v[136:139], v[16:19], 0
    v_mfma_f32_16x16x32_bf16 v[164:167], v[136:139], v[20:23], 0
    s_waitcnt lgkmcnt(2)
    v_mfma_f32_16x16x32_bf16 v[152:155], v[140:143], v[40:43], v[152:155]
    v_mfma_f32_16x16x32_bf16 v[156:159], v[140:143], v[44:47], v[156:159]
    v_mfma_f32_16x16x32_bf16 v[160:163], v[140:143], v[48:51], v[160:163]
    v_mfma_f32_16x16x32_bf16 v[164:167], v[140:143], v[52:55], v[164:167]
    s_waitcnt lgkmcnt(1)
    v_mfma_f32_16x16x32_bf16 v[152:155], v[144:147], v[72:75], v[152:155]
    v_mfma_f32_16x16x32_bf16 v[156:159], v[144:147], v[76:79], v[156:159]
    v_mfma_f32_16x16x32_bf16 v[160:163], v[144:147], v[80:83], v[160:163]
    v_mfma_f32_16x16x32_bf16 v[164:167], v[144:147], v[84:87], v[164:167]
    s_waitcnt lgkmcnt(0)
    v_mfma_f32_16x16x32_bf16 v[152:155], v[148:151], v[104:107], v[152:155]
    v_mfma_f32_16x16x32_bf16 v[156:159], v[148:151], v[108:111], v[156:159]
    v_mfma_f32_16x16x32_bf16 v[160:163], v[148:151], v[112:115], v[160:163]
    v_mfma_f32_16x16x32_bf16 v[164:167], v[148:151], v[116:119], v[164:167]
    v_mfma_f32_16x16x32_bf16 v[8:11], v[136:139], v[24:27], 0
    v_mfma_f32_16x16x32_bf16 v[12:15], v[136:139], v[28:31], 0
    v_mfma_f32_16x16x32_bf16 v[16:19], v[136:139], v[32:35], 0
    v_mfma_f32_16x16x32_bf16 v[20:23], v[136:139], v[36:39], 0
    v_mfma_f32_16x16x32_bf16 v[8:11], v[140:143], v[56:59], v[8:11]
    v_mfma_f32_16x16x32_bf16 v[12:15], v[140:143], v[60:63], v[12:15]
    v_mfma_f32_16x16x32_bf16 v[16:19], v[140:143], v[64:67], v[16:19]
    v_mfma_f32_16x16x32_bf16 v[20:23], v[140:143], v[68:71], v[20:23]
    v_mfma_f32_16x16x32_bf16 v[8:11], v[144:147], v[88:91], v[8:11]
    v_mfma_f32_16x16x32_bf16 v[12:15], v[144:147], v[92:95], v[12:15]
    v_mfma_f32_16x16x32_bf16 v[16:19], v[144:147], v[96:99], v[16:19]
    v_mfma_f32_16x16x32_bf16 v[20:23], v[144:147], v[100:103], v[20:23]
    v_mfma_f32_16x16x32_bf16 v[8:11], v[148:151], v[120:123], v[8:11]
    v_mfma_f32_16x16x32_bf16 v[12:15], v[148:151], v[124:127], v[12:15]
    v_mfma_f32_16x16x32_bf16 v[16:19], v[148:151], v[128:131], v[16:19]
    v_mfma_f32_16x16x32_bf16 v[20:23], v[148:151], v[132:135], v[20:23]
    v_mov_b32 v5, s67
    v_perm_b32 v152, v152, v5, s86
    v_perm_b32 v153, v156, v5, s87
    v_perm_b32 v154, v160, v5, s86
    v_perm_b32 v155, v164, v5, s87
    buffer_store_dwordx4 v[152:155], v1, s[48:51], s63 offen offset:0 sc1
    s_nop 5
    v_perm_b32 v8, v8, v5, s86
    v_perm_b32 v9, v12, v5, s87
    v_perm_b32 v10, v16, v5, s86
    v_perm_b32 v11, v20, v5, s87
    buffer_store_dwordx4 v[8:11], v1, s[48:51], s63 offen offset:1024 sc1
    v_mov_b32 v3, 8456
    v_mov_b32 v4, 1
    ds_write_b32 v3, v4
    s_endpgm
L_gu:
    v_lshrrev_b32 v8, 4, v0
    v_and_b32 v9, 15, v0
    v_mul_u32_u24 v6, 57344, v8
    v_lshl_add_u32 v6, v9, 4, v6
    s_and_b32 s56, s65, 6
    s_add_u32 s56, s56, s3
    s_sub_u32 s56, s56, 2
    s_mul_i32 s62, s56, 917504
    s_lshl_b32 s60, s58, 8
    s_add_u32 s62, s62, s60
    s_waitcnt lgkmcnt(0)
    s_bitcmp0_b32 s65, 0
    s_cselect_b32 s40, s18, s20
    s_cselect_b32 s41, s19, s21
    s_mov_b32 s44, s4
    s_mov_b32 s45, s5
    s_load_dword s66, s[30:31], 0
    s_mov_b32 s48, s30
    s_mov_b32 s49, s31
    v_lshlrev_b32 v10, 11, v8
    v_lshl_add_u32 v10, v9, 4, v10
    s_lshl_b32 s63, s56, 8
    buffer_load_dwordx4 v[2:5], v10, s[44:47], s63 offen
    buffer_load_dwordx4 v[40:43], v6, s[40:43], s62 offen nt
    s_add_u32 s62, s62, 7168
    buffer_load_dwordx4 v[44:47], v6, s[40:43], s62 offen nt
    s_add_u32 s62, s62, 7168
    buffer_load_dwordx4 v[48:51], v6, s[40:43], s62 offen nt
    s_add_u32 s62, s62, 7168
    buffer_load_dwordx4 v[52:55], v6, s[40:43], s62 offen nt
    s_add_u32 s62, s62, 7168
    buffer_load_dwordx4 v[56:59], v6, s[40:43], s62 offen nt
    s_add_u32 s62, s62, 7168
    buffer_load_dwordx4 v[60:63], v6, s[40:43], s62 offen nt
    s_add_u32 s62, s62, 7168
    buffer_load_dwordx4 v[64:67], v6, s[40:43], s62 offen nt
    s_add_u32 s62, s62, 7168
    buffer_load_dwordx4 v[68:71], v6, s[40:43], s62 offen nt
    s_add_u32 s62, s62, 179200
    buffer_load_dwordx4 v[72:75], v6, s[40:43], s62 offen nt
    s_add_u32 s62, s62, 7168
    buffer_load_dwordx4 v[76:79], v6, s[40:43], s62 offen nt
    s_add_u32 s62, s62, 7168
    buffer_load_dwordx4 v[80:83], v6, s[40:43], s62 offen nt
    s_add_u32 s62, s62, 7168
    buffer_load_dwordx4 v[84:87], v6, s[40:43], s62 offen nt
    s_add_u32 s62, s62, 7168
    buffer_load_dwordx4 v[88:91], v6, s[40:43], s62 offen nt
    s_add_u32 s62, s62, 7168
    buffer_load_dwordx4 v[92:95], v6, s[40:43], s62 offen nt
    s_add_u32 s62, s62, 7168
    buffer_load_dwordx4 v[96:99], v6, s[40:43], s62 offen nt
    s_add_u32 s62, s62, 7168
    buffer_load_dwordx4 v[100:103], v6, s[40:43], s62 offen nt
    s_add_u32 s62, s62, 179200
    buffer_load_dwordx4 v[104:107], v6, s[40:43], s62 offen nt
    s_add_u32 s62, s62, 7168
    buffer_load_dwordx4 v[108:111], v6, s[40:43], s62 offen nt
    s_add_u32 s62, s62, 7168
    buffer_load_dwordx4 v[112:115], v6, s[40:43], s62 offen nt
    s_add_u32 s62, s62, 7168
    buffer_load_dwordx4 v[116:119], v6, s[40:43], s62 offen nt
    s_add_u32 s62, s62, 7168
    buffer_load_dwordx4 v[120:123], v6, s[40:43], s62 offen nt
    s_add_u32 s62, s62, 7168
    buffer_load_dwordx4 v[124:127], v6, s[40:43], s62 offen nt
    s_add_u32 s62, s62, 7168
    buffer_load_dwordx4 v[128:131], v6, s[40:43], s62 offen nt
    s_add_u32 s62, s62, 7168
    buffer_load_dwordx4 v[132:135], v6, s[40:43], s62 offen nt
    s_add_u32 s62, s62, 179200
    buffer_load_dwordx4 v[136:139], v6, s[40:43], s62 offen nt
    s_add_u32 s62, s62, 7168
    buffer_load_dwordx4 v[140:143], v6, s[40:43], s62 offen nt
    s_add_u32 s62, s62, 7168
    buffer_load_dwordx4 v[144:147], v6, s[40:43], s62 offen nt
    s_add_u32 s62, s62, 7168
    buffer_load_dwordx4 v[148:151], v6, s[40:43], s62 offen nt
    s_add_u32 s62, s62, 7168
    buffer_load_dwordx4 v[152:155], v6, s[40:43], s62 offen nt
    s_add_u32 s62, s62, 7168
    buffer_load_dwordx4 v[156:159], v6, s[40:43], s62 offen nt
    s_add_u32 s62, s62, 7168
    buffer_load_dwordx4 v[160:163], v6, s[40:43], s62 offen nt
    s_add_u32 s62, s62, 7168
    buffer_load_dwordx4 v[164:167], v6, s[40:43], s62 offen nt
    v_bfe_u32 v7, v0, 2, 2
    v_lshlrev_b32 v7, 8, v7
    v_lshrrev_b32 v11, 4, v0
    v_lshl_add_u32 v7, v11, 4, v7
    s_lshl_b32 s60, s3, 10
    v_add_u32 v7, s60, v7
    v_add_u32 v12, s60, v1
    s_waitcnt lgkmcnt(0)
    s_barrier
    s_mul_i32 s66, s66, 0x19660d
    s_add_u32 s66, s66, 0x3c6ef35f
    s_and_b32 s67, s66, 0xffff
    s_waitcnt vmcnt(32)
    ds_write_b128 v12, v[2:5] offset:9216
    s_lshl_b32 s63, s58, 3
    s_add_u32 s63, s63, s65
    s_lshl_b32 s63, s63, 11
    s_add_u32 s63, s63, 2097152
    s_waitcnt lgkmcnt(0)
    s_waitcnt vmcnt(30)
    v_perm_b32 v8, v44, v40, s52
    v_perm_b32 v12, v44, v40, s53
    v_perm_b32 v16, v45, v41, s52
    v_perm_b32 v20, v45, v41, s53
    v_perm_b32 v24, v46, v42, s52
    v_perm_b32 v28, v46, v42, s53
    v_perm_b32 v32, v47, v43, s52
    v_perm_b32 v36, v47, v43, s53
    s_waitcnt vmcnt(28)
    v_perm_b32 v9, v52, v48, s52
    v_perm_b32 v13, v52, v48, s53
    v_perm_b32 v17, v53, v49, s52
    v_perm_b32 v21, v53, v49, s53
    v_perm_b32 v25, v54, v50, s52
    v_perm_b32 v29, v54, v50, s53
    v_perm_b32 v33, v55, v51, s52
    v_perm_b32 v37, v55, v51, s53
    s_waitcnt vmcnt(26)
    v_perm_b32 v10, v60, v56, s52
    v_perm_b32 v14, v60, v56, s53
    v_perm_b32 v18, v61, v57, s52
    v_perm_b32 v22, v61, v57, s53
    v_perm_b32 v26, v62, v58, s52
    v_perm_b32 v30, v62, v58, s53
    v_perm_b32 v34, v63, v59, s52
    v_perm_b32 v38, v63, v59, s53
    s_waitcnt vmcnt(24)
    v_perm_b32 v11, v68, v64, s52
    v_perm_b32 v15, v68, v64, s53
    v_perm_b32 v19, v69, v65, s52
    v_perm_b32 v23, v69, v65, s53
    v_perm_b32 v27, v70, v66, s52
    v_perm_b32 v31, v70, v66, s53
    v_perm_b32 v35, v71, v67, s52
    v_perm_b32 v39, v71, v67, s53
    s_waitcnt vmcnt(22)
    v_perm_b32 v40, v76, v72, s52
    v_perm_b32 v44, v76, v72, s53
    v_perm_b32 v48, v77, v73, s52
    v_perm_b32 v52, v77, v73, s53
    v_perm_b32 v56, v78, v74, s52
    v_perm_b32 v60, v78, v74, s53
    v_perm_b32 v64, v79, v75, s52
    v_perm_b32 v68, v79, v75, s53
    s_waitcnt vmcnt(20)
    v_perm_b32 v41, v84, v80, s52
    v_perm_b32 v45, v84, v80, s53
    v_perm_b32 v49, v85, v81, s52
    v_perm_b32 v53, v85, v81, s53
    v_perm_b32 v57, v86, v82, s52
    v_perm_b32 v61, v86, v82, s53
    v_perm_b32 v65, v87, v83, s52
    v_perm_b32 v69, v87, v83, s53
    s_waitcnt vmcnt(18)
    v_perm_b32 v42, v92, v88, s52
    v_perm_b32 v46, v92, v88, s53
    v_perm_b32 v50, v93, v89, s52
    v_perm_b32 v54, v93, v89, s53
    v_perm_b32 v58, v94, v90, s52
    v_perm_b32 v62, v94, v90, s53
    v_perm_b32 v66, v95, v91, s52
    v_perm_b32 v70, v95, v91, s53
    s_waitcnt vmcnt(16)
    v_perm_b32 v43, v100, v96, s52
    v_perm_b32 v47, v100, v96, s53
    v_perm_b32 v51, v101, v97, s52
    v_perm_b32 v55, v101, v97, s53
    v_perm_b32 v59, v102, v98, s52
    v_perm_b32 v63, v102, v98, s53
    v_perm_b32 v67, v103, v99, s52
    v_perm_b32 v71, v103, v99, s53
    s_waitcnt vmcnt(14)
    v_perm_b32 v72, v108, v104, s52
    v_perm_b32 v76, v108, v104, s53
    v_perm_b32 v80, v109, v105, s52
    v_perm_b32 v84, v109, v105, s53
    v_perm_b32 v88, v110, v106, s52
    v_perm_b32 v92, v110, v106, s53
    v_perm_b32 v96, v111, v107, s52
    v_perm_b32 v100, v111, v107, s53
    s_waitcnt vmcnt(12)
    v_perm_b32 v73, v116, v112, s52
    v_perm_b32 v77, v116, v112, s53
    v_perm_b32 v81, v117, v113, s52
    v_perm_b32 v85, v117, v113, s53
    v_perm_b32 v89, v118, v114, s52
    v_perm_b32 v93, v118, v114, s53
    v_perm_b32 v97, v119, v115, s52
    v_perm_b32 v101, v119, v115, s53
    s_waitcnt vmcnt(10)
    v_perm_b32 v74, v124, v120, s52
    v_perm_b32 v78, v124, v120, s53
    v_perm_b32 v82, v125, v121, s52
    v_perm_b32 v86, v125, v121, s53
    v_perm_b32 v90, v126, v122, s52
    v_perm_b32 v94, v126, v122, s53
    v_perm_b32 v98, v127, v123, s52
    v_perm_b32 v102, v127, v123, s53
    s_waitcnt vmcnt(8)
    v_perm_b32 v75, v132, v128, s52
    v_perm_b32 v79, v132, v128, s53
    v_perm_b32 v83, v133, v129, s52
    v_perm_b32 v87, v133, v129, s53
    v_perm_b32 v91, v134, v130, s52
    v_perm_b32 v95, v134, v130, s53
    v_perm_b32 v99, v135, v131, s52
    v_perm_b32 v103, v135, v131, s53
    s_waitcnt vmcnt(6)
    v_perm_b32 v104, v140, v136, s52
    v_perm_b32 v108, v140, v136, s53
    v_perm_b32 v112, v141, v137, s52
    v_perm_b32 v116, v141, v137, s53
    v_perm_b32 v120, v142, v138, s52
    v_perm_b32 v124, v142, v138, s53
    v_perm_b32 v128, v143, v139, s52
    v_perm_b32 v132, v143, v139, s53
    s_waitcnt vmcnt(4)
    v_perm_b32 v105, v148, v144, s52
    v_perm_b32 v109, v148, v144, s53
    v_perm_b32 v113, v149, v145, s52
    v_perm_b32 v117, v149, v145, s53
    v_perm_b32 v121, v150, v146, s52
    v_perm_b32 v125, v150, v146, s53
    v_perm_b32 v129, v151, v147, s52
    v_perm_b32 v133, v151, v147, s53
    s_waitcnt vmcnt(2)
    v_perm_b32 v106, v156, v152, s52
    v_perm_b32 v110, v156, v152, s53
    v_perm_b32 v114, v157, v153, s52
    v_perm_b32 v118, v157, v153, s53
    v_perm_b32 v122, v158, v154, s52
    v_perm_b32 v126, v158, v154, s53
    v_perm_b32 v130, v159, v155, s52
    v_perm_b32 v134, v159, v155, s53
    s_waitcnt vmcnt(0)
    v_perm_b32 v107, v164, v160, s52
    v_perm_b32 v111, v164, v160, s53
    v_perm_b32 v115, v165, v161, s52
    v_perm_b32 v119, v165, v161, s53
    v_perm_b32 v123, v166, v162, s52
    v_perm_b32 v127, v166, v162, s53
    v_perm_b32 v131, v167, v163, s52
    v_perm_b32 v135, v167, v163, s53
    ds_read_b128 v[136:139], v7 offset:9216
    ds_read_b128 v[140:143], v7 offset:9280
    ds_read_b128 v[144:147], v7 offset:9344
    ds_read_b128 v[148:151], v7 offset:9408
    s_waitcnt lgkmcnt(3)
    v_mfma_f32_16x16x32_bf16 v[152:155], v[136:139], v[8:11], 0
    v_mfma_f32_16x16x32_bf16 v[156:159], v[136:139], v[12:15], 0
    v_mfma_f32_16x16x32_bf16 v[160:163], v[136:139], v[16:19], 0
    v_mfma_f32_16x16x32_bf16 v[164:167], v[136:139], v[20:23], 0
    s_waitcnt lgkmcnt(2)
    v_mfma_f32_16x16x32_bf16 v[152:155], v[140:143], v[40:43], v[152:155]
    v_mfma_f32_16x16x32_bf16 v[156:159], v[140:143], v[44:47], v[156:159]
    v_mfma_f32_16x16x32_bf16 v[160:163], v[140:143], v[48:51], v[160:163]
    v_mfma_f32_16x16x32_bf16 v[164:167], v[140:143], v[52:55], v[164:167]
    s_waitcnt lgkmcnt(1)
    v_mfma_f32_16x16x32_bf16 v[152:155], v[144:147], v[72:75], v[152:155]
    v_mfma_f32_16x16x32_bf16 v[156:159], v[144:147], v[76:79], v[156:159]
    v_mfma_f32_16x16x32_bf16 v[160:163], v[144:147], v[80:83], v[160:163]
    v_mfma_f32_16x16x32_bf16 v[164:167], v[144:147], v[84:87], v[164:167]
    s_waitcnt lgkmcnt(0)
    v_mfma_f32_16x16x32_bf16 v[152:155], v[148:151], v[104:107], v[152:155]
    v_mfma_f32_16x16x32_bf16 v[156:159], v[148:151], v[108:111], v[156:159]
    v_mfma_f32_16x16x32_bf16 v[160:163], v[148:151], v[112:115], v[160:163]
    v_mfma_f32_16x16x32_bf16 v[164:167], v[148:151], v[116:119], v[164:167]
    v_mfma_f32_16x16x32_bf16 v[8:11], v[136:139], v[24:27], 0
    v_mfma_f32_16x16x32_bf16 v[12:15], v[136:139], v[28:31], 0
    v_mfma_f32_16x16x32_bf16 v[16:19], v[136:139], v[32:35], 0
    v_mfma_f32_16x16x32_bf16 v[20:23], v[136:139], v[36:39], 0
    v_mfma_f32_16x16x32_bf16 v[8:11], v[140:143], v[56:59], v[8:11]
    v_mfma_f32_16x16x32_bf16 v[12:15], v[140:143], v[60:63], v[12:15]
    v_mfma_f32_16x16x32_bf16 v[16:19], v[140:143], v[64:67], v[16:19]
    v_mfma_f32_16x16x32_bf16 v[20:23], v[140:143], v[68:71], v[20:23]
    v_mfma_f32_16x16x32_bf16 v[8:11], v[144:147], v[88:91], v[8:11]
    v_mfma_f32_16x16x32_bf16 v[12:15], v[144:147], v[92:95], v[12:15]
    v_mfma_f32_16x16x32_bf16 v[16:19], v[144:147], v[96:99], v[16:19]
    v_mfma_f32_16x16x32_bf16 v[20:23], v[144:147], v[100:103], v[20:23]
    v_mfma_f32_16x16x32_bf16 v[8:11], v[148:151], v[120:123], v[8:11]
    v_mfma_f32_16x16x32_bf16 v[12:15], v[148:151], v[124:127], v[12:15]
    v_mfma_f32_16x16x32_bf16 v[16:19], v[148:151], v[128:131], v[16:19]
    v_mfma_f32_16x16x32_bf16 v[20:23], v[148:151], v[132:135], v[20:23]
    s_cmp_eq_u32 s3, 2
    s_cbranch_scc1 L_gum2
    s_nop 7
    v_mov_b32 v153, v156
    v_mov_b32 v154, v160
    v_mov_b32 v155, v164
    ds_write_b128 v1, v[152:155] offset:13312
    s_nop 7
    v_mov_b32 v9, v12
    v_mov_b32 v10, v16
    v_mov_b32 v11, v20
    ds_write_b128 v1, v[8:11] offset:14336
    s_waitcnt lgkmcnt(0)
    v_mov_b32 v3, 8460
    v_mov_b32 v4, 1
    ds_write_b32 v3, v4
    s_branch L_red
L_gum2:
    v_mov_b32 v3, 8460
L_wf3:
    ds_read_b32 v4, v3
    s_waitcnt lgkmcnt(0)
    v_readfirstlane_b32 s60, v4
    s_cmp_lg_u32 s60, 0
    s_cbranch_scc1 L_wf3_ok
    s_sleep 2
    s_branch L_wf3
L_wf3_ok:
    ds_read_b128 v[40:43], v1 offset:13312
    ds_read_b128 v[44:47], v1 offset:14336
    s_waitcnt lgkmcnt(0)
    v_add_f32 v152, v152, v40
    v_add_f32 v156, v156, v41
    v_add_f32 v160, v160, v42
    v_add_f32 v164, v164, v43
    v_add_f32 v8, v8, v44
    v_add_f32 v12, v12, v45
    v_add_f32 v16, v16, v46
    v_add_f32 v20, v20, v47
    v_mov_b32 v5, s67
    v_perm_b32 v152, v152, v5, s86
    v_perm_b32 v153, v156, v5, s87
    v_perm_b32 v154, v160, v5, s86
    v_perm_b32 v155, v164, v5, s87
    buffer_store_dwordx4 v[152:155], v1, s[48:51], s63 offen offset:0 sc1
    s_nop 5
    v_perm_b32 v8, v8, v5, s86
    v_perm_b32 v9, v12, v5, s87
    v_perm_b32 v10, v16, v5, s86
    v_perm_b32 v11, v20, v5, s87
    buffer_store_dwordx4 v[8:11], v1, s[48:51], s63 offen offset:1024 sc1
    v_lshrrev_b32 v4, 5, v0
    v_bfe_u32 v5, v0, 2, 2
    v_and_b32 v3, 3, v0
    v_bfe_u32 v6, v0, 4, 1
    v_lshlrev_b32 v2, 11, v4
    v_lshl_add_u32 v2, v6, 12, v2
    v_lshl_add_u32 v2, v5, 8, v2
    v_lshl_add_u32 v2, v3, 4, v2
    s_lshl_b32 s63, s58, 14
    s_lshr_b32 s60, s65, 2
    s_lshl_b32 s60, s60, 10
    s_add_u32 s63, s63, s60
    s_and_b32 s60, s65, 3
    s_lshl_b32 s60, s60, 6
    s_add_u32 s63, s63, s60
    s_add_u32 s63, s63, 2097152
    v_lshlrev_b32 v5, 9, v5
    v_lshl_add_u32 v3, v3, 5, v5
    s_mov_b32 s64, 3
L_pg:
    s_bitcmp1_b32 s64, 0
    s_cbranch_scc0 L_pg_s0
    s_add_u32 s61, s63, 0
    buffer_load_dwordx4 v[40:43], v2, s[48:51], s61 offen sc1
L_pg_s0:
    s_bitcmp1_b32 s64, 1
    s_cbranch_scc0 L_pg_s1
    s_add_u32 s61, s63, 8192
    buffer_load_dwordx4 v[44:47], v2, s[48:51], s61 offen sc1
L_pg_s1:
    s_mov_b32 s64, 0
    s_waitcnt vmcnt(0)
    v_perm_b32 v32, v41, v40, s88
    v_perm_b32 v33, v43, v42, s88
    v_cmp_ne_u32 vcc, s67, v32
    v_cmp_ne_u32 s[68:69], s67, v33
    s_or_b64 s[68:69], s[68:69], vcc
    s_cselect_b32 s60, 1, 0
    s_or_b32 s64, s64, s60
    v_perm_b32 v32, v45, v44, s88
    v_perm_b32 v33, v47, v46, s88
    v_cmp_ne_u32 vcc, s67, v32
    v_cmp_ne_u32 s[68:69], s67, v33
    s_or_b64 s[68:69], s[68:69], vcc
    s_cselect_b32 s60, 2, 0
    s_or_b32 s64, s64, s60
    s_cmp_eq_u32 s64, 0
    s_cbranch_scc1 L_pg_ok
    s_sleep 16
    s_branch L_pg
L_pg_ok:
    v_and_b32 v40, 0xffffff00, v40
    v_and_b32 v41, 0xffffff00, v41
    v_and_b32 v42, 0xffffff00, v42
    v_and_b32 v43, 0xffffff00, v43
    v_and_b32 v44, 0xffffff00, v44
    v_and_b32 v45, 0xffffff00, v45
    v_and_b32 v46, 0xffffff00, v46
    v_and_b32 v47, 0xffffff00, v47
    v_add_f32 v40, v40, v44
    v_add_f32 v41, v41, v45
    v_add_f32 v42, v42, v46
    v_add_f32 v43, v43, v47
    v_mov_b32 v44, v40
    v_mov_b32 v45, v41
    v_mov_b32 v46, v42
    v_mov_b32 v47, v43
    v_permlane16_swap_b32 v40, v44
    v_permlane16_swap_b32 v41, v45
    v_permlane16_swap_b32 v42, v46
    v_permlane16_swap_b32 v43, v47
    v_add_f32 v40, v40, v44
    v_add_f32 v41, v41, v45
    v_add_f32 v42, v42, v46
    v_add_f32 v43, v43, v47
    v_mov_b32 v44, v40
    v_mov_b32 v45, v41
    v_mov_b32 v46, v42
    v_mov_b32 v47, v43
    v_permlane32_swap_b32 v40, v44
    v_permlane32_swap_b32 v41, v45
    v_permlane32_swap_b32 v42, v46
    v_permlane32_swap_b32 v43, v47
    v_cvt_pk_bf16_f32 v40, v40, v40
    v_lshlrev_b32 v40, 16, v40
    v_cvt_pk_bf16_f32 v41, v41, v41
    v_lshlrev_b32 v41, 16, v41
    v_cvt_pk_bf16_f32 v42, v42, v42
    v_lshlrev_b32 v42, 16, v42
    v_cvt_pk_bf16_f32 v43, v43, v43
    v_lshlrev_b32 v43, 16, v43
    v_cvt_pk_bf16_f32 v44, v44, v44
    v_lshlrev_b32 v44, 16, v44
    v_cvt_pk_bf16_f32 v45, v45, v45
    v_lshlrev_b32 v45, 16, v45
    v_cvt_pk_bf16_f32 v46, v46, v46
    v_lshlrev_b32 v46, 16, v46
    v_cvt_pk_bf16_f32 v47, v47, v47
    v_lshlrev_b32 v47, 16, v47
    v_mul_f32 v48, 0xbfb8aa3b, v40
    v_exp_f32 v48, v48
    s_nop 0
    v_add_f32 v48, 1.0, v48
    v_rcp_f32 v48, v48
    s_nop 0
    v_mul_f32 v49, 0xbfb8aa3b, v41
    v_exp_f32 v49, v49
    s_nop 0
    v_add_f32 v49, 1.0, v49
    v_rcp_f32 v49, v49
    s_nop 0
    v_mul_f32 v50, 0xbfb8aa3b, v42
    v_exp_f32 v50, v50
    s_nop 0
    v_add_f32 v50, 1.0, v50
    v_rcp_f32 v50, v50
    s_nop 0
    v_mul_f32 v51, 0xbfb8aa3b, v43
    v_exp_f32 v51, v51
    s_nop 0
    v_add_f32 v51, 1.0, v51
    v_rcp_f32 v51, v51
    s_nop 0
    v_mul_f32 v40, v40, v48
    v_mul_f32 v41, v41, v49
    v_mul_f32 v42, v42, v50
    v_mul_f32 v43, v43, v51
    v_cvt_pk_bf16_f32 v40, v40, v40
    v_lshlrev_b32 v40, 16, v40
    v_cvt_pk_bf16_f32 v41, v41, v41
    v_lshlrev_b32 v41, 16, v41
    v_cvt_pk_bf16_f32 v42, v42, v42
    v_lshlrev_b32 v42, 16, v42
    v_cvt_pk_bf16_f32 v43, v43, v43
    v_lshlrev_b32 v43, 16, v43
    v_mul_f32 v40, v40, v44
    v_mul_f32 v41, v41, v45
    v_mul_f32 v42, v42, v46
    v_mul_f32 v43, v43, v47
    v_cvt_pk_bf16_f32 v40, v40, v41
    v_cvt_pk_bf16_f32 v42, v42, v43
    v_mov_b32 v41, s66
    v_mov_b32 v43, s66
    s_lshl_b32 s63, s58, 11
    s_and_b32 s60, s65, 3
    s_lshl_b32 s60, s60, 7
    s_add_u32 s63, s63, s60
    s_lshr_b32 s60, s65, 2
    s_lshl_b32 s60, s60, 4
    s_add_u32 s63, s63, s60
    s_add_u32 s63, s63, 327680
    s_mov_b64 exec, 0xffff
    buffer_store_dwordx4 v[40:43], v3, s[48:51], s63 offen sc1
    s_mov_b64 exec, -1
    v_mov_b32 v4, 8452
    v_mov_b32 v5, 1
    ds_write_b32 v4, v5
    s_endpgm
L_red:
    v_lshlrev_b32 v2, 5, v0
    s_lshl_b32 s63, s57, 11
    buffer_load_dwordx4 v[40:43], v2, s[44:47], s63 offen
    buffer_load_dwordx4 v[44:47], v2, s[44:47], s63 offen offset:16
    global_load_dwordx4 v[48:51], v2, s[24:25]
    global_load_dwordx4 v[52:55], v2, s[24:25] offset:16
    global_load_dwordx4 v[56:59], v2, s[16:17]
    global_load_dwordx4 v[60:63], v2, s[16:17] offset:16
    s_and_b32 s60, s2, 7
    s_lshl_b32 s62, s60, 8
    s_add_u32 s62, s62, s63
    s_lshl_b32 s63, s60, 11
    s_lshl_b32 s60, s57, 8
    s_add_u32 s63, s63, s60
    s_lshr_b32 s60, s2, 6
    s_lshl_b32 s60, s60, 6
    s_add_u32 s62, s62, s60
    s_add_u32 s63, s63, s60
    s_bfe_u32 s60, s2, 0x10005
    s_lshl_b32 s61, s60, 3
    s_add_u32 s62, s62, s61
    s_lshl_b32 s61, s60, 10
    s_add_u32 s63, s63, s61
    v_and_b32 v3, 3, v0
    v_lshlrev_b32 v3, 4, v3
    buffer_load_dwordx2 v[28:29], v3, s[44:47], s62 offen
    v_lshrrev_b32 v4, 2, v0
    v_lshl_add_u32 v4, v4, 14, v3
    v_add_u32 v3, s62, v3
    s_waitcnt vmcnt(1)
    v_dot2_f32_bf16 v31, v40, v56, 0
    v_dot2_f32_bf16 v31, v41, v57, v31
    v_dot2_f32_bf16 v31, v42, v58, v31
    v_dot2_f32_bf16 v31, v43, v59, v31
    v_dot2_f32_bf16 v31, v44, v60, v31
    v_dot2_f32_bf16 v31, v45, v61, v31
    v_dot2_f32_bf16 v31, v46, v62, v31
    v_dot2_f32_bf16 v31, v47, v63, v31
    v_lshlrev_b32 v64, 16, v40
    v_lshlrev_b32 v65, 16, v48
    v_and_b32 v66, 0xffff0000, v40
    v_and_b32 v67, 0xffff0000, v48
    v_mul_f32 v64, v64, v65
    v_mul_f32 v66, v66, v67
    v_cvt_pk_bf16_f32 v64, v64, v66
    v_and_b32 v65, 0xffff0000, v64
    v_lshlrev_b32 v64, 16, v64
    v_add_f32 v30, v64, v65
    v_lshlrev_b32 v64, 16, v41
    v_lshlrev_b32 v65, 16, v49
    v_and_b32 v66, 0xffff0000, v41
    v_and_b32 v67, 0xffff0000, v49
    v_mul_f32 v64, v64, v65
    v_mul_f32 v66, v66, v67
    v_cvt_pk_bf16_f32 v64, v64, v66
    v_and_b32 v65, 0xffff0000, v64
    v_lshlrev_b32 v64, 16, v64
    v_add_f32 v30, v30, v64
    v_add_f32 v30, v30, v65
    v_lshlrev_b32 v64, 16, v42
    v_lshlrev_b32 v65, 16, v50
    v_and_b32 v66, 0xffff0000, v42
    v_and_b32 v67, 0xffff0000, v50
    v_mul_f32 v64, v64, v65
    v_mul_f32 v66, v66, v67
    v_cvt_pk_bf16_f32 v64, v64, v66
    v_and_b32 v65, 0xffff0000, v64
    v_lshlrev_b32 v64, 16, v64
    v_add_f32 v30, v30, v64
    v_add_f32 v30, v30, v65
    v_lshlrev_b32 v64, 16, v43
    v_lshlrev_b32 v65, 16, v51
    v_and_b32 v66, 0xffff0000, v43
    v_and_b32 v67, 0xffff0000, v51
    v_mul_f32 v64, v64, v65
    v_mul_f32 v66, v66, v67
    v_cvt_pk_bf16_f32 v64, v64, v66
    v_and_b32 v65, 0xffff0000, v64
    v_lshlrev_b32 v64, 16, v64
    v_add_f32 v30, v30, v64
    v_add_f32 v30, v30, v65
    v_lshlrev_b32 v64, 16, v44
    v_lshlrev_b32 v65, 16, v52
    v_and_b32 v66, 0xffff0000, v44
    v_and_b32 v67, 0xffff0000, v52
    v_mul_f32 v64, v64, v65
    v_mul_f32 v66, v66, v67
    v_cvt_pk_bf16_f32 v64, v64, v66
    v_and_b32 v65, 0xffff0000, v64
    v_lshlrev_b32 v64, 16, v64
    v_add_f32 v30, v30, v64
    v_add_f32 v30, v30, v65
    v_lshlrev_b32 v64, 16, v45
    v_lshlrev_b32 v65, 16, v53
    v_and_b32 v66, 0xffff0000, v45
    v_and_b32 v67, 0xffff0000, v53
    v_mul_f32 v64, v64, v65
    v_mul_f32 v66, v66, v67
    v_cvt_pk_bf16_f32 v64, v64, v66
    v_and_b32 v65, 0xffff0000, v64
    v_lshlrev_b32 v64, 16, v64
    v_add_f32 v30, v30, v64
    v_add_f32 v30, v30, v65
    v_lshlrev_b32 v64, 16, v46
    v_lshlrev_b32 v65, 16, v54
    v_and_b32 v66, 0xffff0000, v46
    v_and_b32 v67, 0xffff0000, v54
    v_mul_f32 v64, v64, v65
    v_mul_f32 v66, v66, v67
    v_cvt_pk_bf16_f32 v64, v64, v66
    v_and_b32 v65, 0xffff0000, v64
    v_lshlrev_b32 v64, 16, v64
    v_add_f32 v30, v30, v64
    v_add_f32 v30, v30, v65
    v_lshlrev_b32 v64, 16, v47
    v_lshlrev_b32 v65, 16, v55
    v_and_b32 v66, 0xffff0000, v47
    v_and_b32 v67, 0xffff0000, v55
    v_mul_f32 v64, v64, v65
    v_mul_f32 v66, v66, v67
    v_cvt_pk_bf16_f32 v64, v64, v66
    v_and_b32 v65, 0xffff0000, v64
    v_lshlrev_b32 v64, 16, v64
    v_add_f32 v30, v30, v64
    v_add_f32 v30, v30, v65
    s_nop 1
    v_add_f32_dpp v31, v31, v31 row_ror:8 row_mask:0xf bank_mask:0xf
    v_add_f32_dpp v30, v30, v30 row_ror:8 row_mask:0xf bank_mask:0xf
    s_nop 1
    v_add_f32_dpp v31, v31, v31 row_ror:4 row_mask:0xf bank_mask:0xf
    v_add_f32_dpp v30, v30, v30 row_ror:4 row_mask:0xf bank_mask:0xf
    s_nop 1
    v_add_f32_dpp v31, v31, v31 row_ror:2 row_mask:0xf bank_mask:0xf
    v_add_f32_dpp v30, v30, v30 row_ror:2 row_mask:0xf bank_mask:0xf
    s_nop 1
    v_add_f32_dpp v31, v31, v31 row_ror:1 row_mask:0xf bank_mask:0xf
    v_add_f32_dpp v30, v30, v30 row_ror:1 row_mask:0xf bank_mask:0xf
    v_mov_b32 v64, v31
    v_mov_b32 v65, v30
    s_nop 0
    v_permlane32_swap_b32 v31, v64
    v_permlane32_swap_b32 v30, v65
    v_add_f32 v31, v31, v64
    v_add_f32 v30, v30, v65
    v_mov_b32 v64, v31
    v_mov_b32 v65, v30
    s_nop 0
    v_permlane16_swap_b32 v31, v64
    v_permlane16_swap_b32 v30, v65
    v_add_f32 v31, v31, v64
    v_add_f32 v30, v30, v65
    v_cvt_pk_bf16_f32 v31, v31, v31
    v_lshlrev_b32 v31, 16, v31
    v_cvt_pk_bf16_f32 v30, v30, v30
    v_lshlrev_b32 v30, 16, v30
    v_mul_f32 v64, 0xbfb8aa3b, v31
    v_exp_f32 v64, v64
    s_nop 0
    v_add_f32 v64, 1.0, v64
    v_rcp_f32 v64, v64
    s_nop 0
    v_cvt_pk_bf16_f32 v31, v64, v64
    v_lshlrev_b32 v31, 16, v31
    v_mul_f32 v64, 0xbfb8aa3b, v30
    v_exp_f32 v64, v64
    s_nop 0
    v_add_f32 v64, 1.0, v64
    v_rcp_f32 v64, v64
    s_nop 0
    v_cvt_pk_bf16_f32 v30, v64, v64
    v_lshlrev_b32 v30, 16, v30
    v_mov_b32 v5, s67
    v_mov_b32 v6, 0
    v_perm_b32 v44, v6, v5, s86
    v_perm_b32 v45, v6, v5, s87
    v_perm_b32 v46, v6, v5, s86
    v_perm_b32 v47, v6, v5, s87
    s_add_u32 s56, s63, 4194304
    s_cmp_ge_u32 s58, 28
    s_cbranch_scc1 L_wf2_ok
    v_mov_b32 v36, 8456
L_wf2:
    ds_read_b32 v37, v36
    s_waitcnt lgkmcnt(0)
    v_readfirstlane_b32 s60, v37
    s_cmp_lg_u32 s60, 0
    s_cbranch_scc1 L_wf2_ok
    s_sleep 32
    s_branch L_wf2
L_wf2_ok:
    s_mov_b32 s64, 3
L_pd:
    s_bitcmp1_b32 s64, 0
    s_cbranch_scc0 L_pd_s0
    s_add_u32 s61, s56, 0
    buffer_load_dwordx4 v[40:43], v4, s[48:51], s61 offen sc1
L_pd_s0:
    s_bitcmp1_b32 s64, 1
    s_cbranch_scc0 L_pd_s1
    s_add_u32 s61, s56, 262144
    s_mov_b32 exec_hi, 0xffff
    buffer_load_dwordx4 v[44:47], v4, s[48:51], s61 offen sc1
    s_mov_b64 exec, -1
L_pd_s1:
    s_mov_b32 s64, 0
    s_waitcnt vmcnt(0)
    v_perm_b32 v36, v41, v40, s88
    v_perm_b32 v37, v43, v42, s88
    v_cmp_ne_u32 vcc, s67, v36
    v_cmp_ne_u32 s[68:69], s67, v37
    s_or_b64 s[68:69], s[68:69], vcc
    s_cselect_b32 s60, 1, 0
    s_or_b32 s64, s64, s60
    v_perm_b32 v36, v45, v44, s88
    v_perm_b32 v37, v47, v46, s88
    v_cmp_ne_u32 vcc, s67, v36
    v_cmp_ne_u32 s[68:69], s67, v37
    s_or_b64 s[68:69], s[68:69], vcc
    s_cselect_b32 s60, 2, 0
    s_or_b32 s64, s64, s60
    s_cmp_eq_u32 s64, 0
    s_cbranch_scc1 L_pd_ok
    s_sleep 8
    s_branch L_pd
L_pd_ok:
    v_and_b32 v40, 0xffffff00, v40
    v_and_b32 v41, 0xffffff00, v41
    v_and_b32 v42, 0xffffff00, v42
    v_and_b32 v43, 0xffffff00, v43
    v_and_b32 v44, 0xffffff00, v44
    v_and_b32 v45, 0xffffff00, v45
    v_and_b32 v46, 0xffffff00, v46
    v_and_b32 v47, 0xffffff00, v47
    v_add_f32 v40, v40, v44
    v_add_f32 v41, v41, v45
    v_add_f32 v42, v42, v46
    v_add_f32 v43, v43, v47
    v_add_f32_dpp v40, v40, v40 row_ror:4 row_mask:0xf bank_mask:0xf
    v_add_f32_dpp v41, v41, v41 row_ror:4 row_mask:0xf bank_mask:0xf
    v_add_f32_dpp v42, v42, v42 row_ror:4 row_mask:0xf bank_mask:0xf
    v_add_f32_dpp v43, v43, v43 row_ror:4 row_mask:0xf bank_mask:0xf
    v_add_f32_dpp v40, v40, v40 row_ror:8 row_mask:0xf bank_mask:0xf
    v_add_f32_dpp v41, v41, v41 row_ror:8 row_mask:0xf bank_mask:0xf
    v_add_f32_dpp v42, v42, v42 row_ror:8 row_mask:0xf bank_mask:0xf
    v_add_f32_dpp v43, v43, v43 row_ror:8 row_mask:0xf bank_mask:0xf
    v_mov_b32 v44, v40
    v_mov_b32 v45, v41
    v_mov_b32 v46, v42
    v_mov_b32 v47, v43
    v_permlane16_swap_b32 v40, v44
    v_permlane16_swap_b32 v41, v45
    v_permlane16_swap_b32 v42, v46
    v_permlane16_swap_b32 v43, v47
    v_add_f32 v40, v40, v44
    v_add_f32 v41, v41, v45
    v_add_f32 v42, v42, v46
    v_add_f32 v43, v43, v47
    v_mov_b32 v44, v40
    v_mov_b32 v45, v41
    v_mov_b32 v46, v42
    v_mov_b32 v47, v43
    v_permlane32_swap_b32 v40, v44
    v_permlane32_swap_b32 v41, v45
    v_permlane32_swap_b32 v42, v46
    v_permlane32_swap_b32 v43, v47
    v_add_f32 v40, v40, v44
    v_add_f32 v41, v41, v45
    v_add_f32 v42, v42, v46
    v_add_f32 v43, v43, v47
    v_cvt_pk_bf16_f32 v40, v40, v41
    v_and_b32 v41, 0xffff0000, v40
    v_lshlrev_b32 v40, 16, v40
    v_cvt_pk_bf16_f32 v42, v42, v43
    v_and_b32 v43, 0xffff0000, v42
    v_lshlrev_b32 v42, 16, v42
    v_mul_f32 v40, v40, v31
    v_mul_f32 v41, v41, v31
    v_mul_f32 v42, v42, v31
    v_mul_f32 v43, v43, v31
    v_cvt_pk_bf16_f32 v40, v40, v41
    v_and_b32 v41, 0xffff0000, v40
    v_lshlrev_b32 v40, 16, v40
    v_cvt_pk_bf16_f32 v42, v42, v43
    v_and_b32 v43, 0xffff0000, v42
    v_lshlrev_b32 v42, 16, v42
    v_lshlrev_b32 v32, 16, v28
    v_and_b32 v33, 0xffff0000, v28
    v_lshlrev_b32 v34, 16, v29
    v_and_b32 v35, 0xffff0000, v29
    v_add_f32 v32, v32, v40
    v_add_f32 v33, v33, v41
    v_add_f32 v34, v34, v42
    v_add_f32 v35, v35, v43
    v_cvt_pk_bf16_f32 v32, v32, v33
    v_and_b32 v33, 0xffff0000, v32
    v_lshlrev_b32 v32, 16, v32
    v_cvt_pk_bf16_f32 v34, v34, v35
    v_and_b32 v35, 0xffff0000, v34
    v_lshlrev_b32 v34, 16, v34
    v_sub_f32 v36, 1.0, v30
    v_cvt_pk_bf16_f32 v36, v36, v36
    v_lshlrev_b32 v36, 16, v36
    v_mul_f32 v32, v36, v32
    v_mul_f32 v33, v36, v33
    v_mul_f32 v34, v36, v34
    v_mul_f32 v35, v36, v35
    v_cvt_pk_bf16_f32 v32, v32, v33
    v_and_b32 v33, 0xffff0000, v32
    v_lshlrev_b32 v32, 16, v32
    v_cvt_pk_bf16_f32 v34, v34, v35
    v_and_b32 v35, 0xffff0000, v34
    v_lshlrev_b32 v34, 16, v34
    s_add_u32 s56, s63, 5242880
    s_barrier
    s_barrier
    s_mov_b32 s64, 3
L_pw:
    s_bitcmp1_b32 s64, 0
    s_cbranch_scc0 L_pw_s0
    s_add_u32 s61, s56, 0
    buffer_load_dwordx4 v[40:43], v4, s[48:51], s61 offen sc1
L_pw_s0:
    s_bitcmp1_b32 s64, 1
    s_cbranch_scc0 L_pw_s1
    s_add_u32 s61, s56, 262144
    buffer_load_dwordx4 v[44:47], v4, s[48:51], s61 offen sc1
L_pw_s1:
    s_mov_b32 s64, 0
    s_waitcnt vmcnt(0)
    v_perm_b32 v36, v41, v40, s88
    v_perm_b32 v37, v43, v42, s88
    v_cmp_ne_u32 vcc, s67, v36
    v_cmp_ne_u32 s[68:69], s67, v37
    s_or_b64 s[68:69], s[68:69], vcc
    s_cselect_b32 s60, 1, 0
    s_or_b32 s64, s64, s60
    v_perm_b32 v36, v45, v44, s88
    v_perm_b32 v37, v47, v46, s88
    v_cmp_ne_u32 vcc, s67, v36
    v_cmp_ne_u32 s[68:69], s67, v37
    s_or_b64 s[68:69], s[68:69], vcc
    s_cselect_b32 s60, 2, 0
    s_or_b32 s64, s64, s60
    s_cmp_eq_u32 s64, 0
    s_cbranch_scc1 L_pw_ok
    s_sleep 1
    s_branch L_pw
L_pw_ok:
    v_and_b32 v40, 0xffffff00, v40
    v_and_b32 v41, 0xffffff00, v41
    v_and_b32 v42, 0xffffff00, v42
    v_and_b32 v43, 0xffffff00, v43
    v_and_b32 v44, 0xffffff00, v44
    v_and_b32 v45, 0xffffff00, v45
    v_and_b32 v46, 0xffffff00, v46
    v_and_b32 v47, 0xffffff00, v47
    v_add_f32 v40, v40, v44
    v_add_f32 v41, v41, v45
    v_add_f32 v42, v42, v46
    v_add_f32 v43, v43, v47
    v_add_f32_dpp v40, v40, v40 row_ror:4 row_mask:0xf bank_mask:0xf
    v_add_f32_dpp v41, v41, v41 row_ror:4 row_mask:0xf bank_mask:0xf
    v_add_f32_dpp v42, v42, v42 row_ror:4 row_mask:0xf bank_mask:0xf
    v_add_f32_dpp v43, v43, v43 row_ror:4 row_mask:0xf bank_mask:0xf
    v_add_f32_dpp v40, v40, v40 row_ror:8 row_mask:0xf bank_mask:0xf
    v_add_f32_dpp v41, v41, v41 row_ror:8 row_mask:0xf bank_mask:0xf
    v_add_f32_dpp v42, v42, v42 row_ror:8 row_mask:0xf bank_mask:0xf
    v_add_f32_dpp v43, v43, v43 row_ror:8 row_mask:0xf bank_mask:0xf
    v_mov_b32 v44, v40
    v_mov_b32 v45, v41
    v_mov_b32 v46, v42
    v_mov_b32 v47, v43
    v_permlane16_swap_b32 v40, v44
    v_permlane16_swap_b32 v41, v45
    v_permlane16_swap_b32 v42, v46
    v_permlane16_swap_b32 v43, v47
    v_add_f32 v40, v40, v44
    v_add_f32 v41, v41, v45
    v_add_f32 v42, v42, v46
    v_add_f32 v43, v43, v47
    v_mov_b32 v44, v40
    v_mov_b32 v45, v41
    v_mov_b32 v46, v42
    v_mov_b32 v47, v43
    v_permlane32_swap_b32 v40, v44
    v_permlane32_swap_b32 v41, v45
    v_permlane32_swap_b32 v42, v46
    v_permlane32_swap_b32 v43, v47
    v_add_f32 v40, v40, v44
    v_add_f32 v41, v41, v45
    v_add_f32 v42, v42, v46
    v_add_f32 v43, v43, v47
    v_cvt_pk_bf16_f32 v40, v40, v41
    v_and_b32 v41, 0xffff0000, v40
    v_lshlrev_b32 v40, 16, v40
    v_cvt_pk_bf16_f32 v42, v42, v43
    v_and_b32 v43, 0xffff0000, v42
    v_lshlrev_b32 v42, 16, v42
    v_mul_f32 v40, v40, v30
    v_mul_f32 v41, v41, v30
    v_mul_f32 v42, v42, v30
    v_mul_f32 v43, v43, v30
    v_cvt_pk_bf16_f32 v40, v40, v41
    v_and_b32 v41, 0xffff0000, v40
    v_lshlrev_b32 v40, 16, v40
    v_cvt_pk_bf16_f32 v42, v42, v43
    v_and_b32 v43, 0xffff0000, v42
    v_lshlrev_b32 v42, 16, v42
    v_add_f32 v40, v40, v32
    v_add_f32 v41, v41, v33
    v_add_f32 v42, v42, v34
    v_add_f32 v43, v43, v35
    v_cvt_pk_bf16_f32 v40, v40, v41
    v_cvt_pk_bf16_f32 v41, v42, v43
    s_mov_b64 exec, 0xf
    global_store_dwordx2 v3, v[40:41], s[26:27]
    s_cmp_lg_u32 s2, 0
    s_cbranch_scc1 L_nobump
    s_mov_b64 exec, 1
    v_mov_b32 v5, 0
    v_mov_b32 v6, s66
    global_store_dword v5, v6, s[30:31] sc1
L_nobump:
    s_mov_b64 exec, -1
L_end:
    s_endpgm
.section .rodata,"a"
.p2align 6
.amdhsa_kernel gated_mix__mha_block_cached__moe_arch_mod__decode_kernel
  .amdhsa_next_free_vgpr 168
  .amdhsa_next_free_sgpr 96
  .amdhsa_accum_offset 168
  .amdhsa_group_segment_fixed_size 0
  .amdhsa_kernarg_size 112
  .amdhsa_user_sgpr_count 2
  .amdhsa_user_sgpr_kernarg_segment_ptr 1
  .amdhsa_system_sgpr_workgroup_id_x 1
.end_amdhsa_kernel
```
